```python
import torch

def _softmax(x, axis=-1):
    return torch.softmax(x, dim=axis)

def _gelu(x):
    return torch.nn.functional.gelu(x, approximate='tanh')

def _silu(x):
    return torch.nn.functional.silu(x)

def _sigmoid(x):
    return torch.sigmoid(x)

def _layernorm(x, axis=-1, eps=1e-05):
    m = x.mean(dim=axis, keepdim=True)
    v = x.var(dim=axis, keepdim=True, unbiased=False)
    return (x - m) / torch.sqrt(v + eps)

def _scatter_add(tgt, idx, src, axis=0):
    return tgt.clone().index_add_(axis, idx, src)

def _segment_sum(src, seg, n):
    out = torch.zeros((n,) + src.shape[1:], dtype=src.dtype)
    return out.index_add_(0, seg, src)

def _pad(x, pw):
    flat = tuple((v for pair in reversed(pw) for v in pair))
    return torch.nn.functional.pad(x, flat)
kernel_name = 'adaLN_cond__compressed_kv_cla__glu_gated_geglu__decode'

def setup_inputs():

    _w = lambda a: (lambda t: t.to(torch.bfloat16) if t.is_floating_point() else t)(torch.as_tensor(a))

    def _A_setup():
        B, H, Sq, Sk, D, M = (4, 32, 1, 4096, 128, 640)
        Dc = 4 * D
        return {'x': _w((lambda *s: torch.randn(*s, dtype=torch.bfloat16) * 0.1)(B, Sq, M)), 'c_kv': _w((lambda *s: torch.randn(*s, dtype=torch.bfloat16) * 6.4)(B, Sk, Dc)), 'w_q': _w((lambda *s: torch.randn(*s, dtype=torch.bfloat16) * 0.8)(M, H, D) * M ** (-0.5)), 'w_uk': _w((lambda *s: torch.randn(*s, dtype=torch.bfloat16) * 0.8)(Dc, H, D) * Dc ** (-0.5)), 'w_uv': _w((lambda *s: torch.randn(*s, dtype=torch.bfloat16) * 6.4)(Dc, H, D) * Dc ** (-0.5)), 'w_o': _w((lambda *s: torch.randn(*s, dtype=torch.bfloat16) * 6.4)(H, D, M) * (H * D) ** (-0.5))}
    _A_in = _A_setup()

    def _B_setup():
        B, S, Dm, Df = (4, 1, 640, 1728)
        return {'x': _w((lambda *s: torch.randn(*s, dtype=torch.bfloat16) * 0.1)(B, S, Dm)), 'w_gate': _w((lambda *s: torch.randn(*s, dtype=torch.bfloat16) * 12.8)(Dm, Df) * Dm ** (-0.5)), 'w_up': _w((lambda *s: torch.randn(*s, dtype=torch.bfloat16) * 12.8)(Dm, Df) * Dm ** (-0.5)), 'w_down': _w((lambda *s: torch.randn(*s, dtype=torch.bfloat16) * 12.8)(Df, Dm) * Df ** (-0.5))}
    _B_in = _B_setup()
    return {'A_x': _A_in['x'], 'A_c_kv': _A_in['c_kv'], 'A_w_q': _A_in['w_q'], 'A_w_uk': _A_in['w_uk'], 'A_w_uv': _A_in['w_uv'], 'A_w_o': _A_in['w_o'], 'B_x': _B_in['x'], 'B_w_gate': _B_in['w_gate'], 'B_w_up': _B_in['w_up'], 'B_w_down': _B_in['w_down'], 'c': _w((lambda *s: torch.randn(*s, dtype=torch.bfloat16) * 0.1)(4, 640) * 8.0), 'w_mod': _w((lambda *s: torch.randn(*s, dtype=torch.bfloat16) * 0.1)(640, 6 * 640) * 640 ** (-0.5) * 8.0)}

def reference(A_x, A_c_kv, A_w_q, A_w_uk, A_w_uv, A_w_o, B_x, B_w_gate, B_w_up, B_w_down, c, w_mod):

    def _A_ref(x, c_kv, w_q, w_uk, w_uv, w_o):
        B, Sq, M = (x.shape[0], x.shape[1], x.shape[2])
        Sk = c_kv.shape[1]
        H, D = (w_q.shape[1], w_q.shape[2])
        q = torch.einsum('bqm,mhd->bhqd', x, w_q)
        k = torch.einsum('bkc,chd->bhkd', c_kv, w_uk)
        v = torch.einsum('bkc,chd->bhkd', c_kv, w_uv)
        scores = torch.einsum('bhqd,bhkd->bhqk', q, k) * D ** (-0.5)
        off = Sk - Sq
        qi = torch.arange(Sq)[:, None]
        kj = torch.arange(Sk)[None, :]
        cmask = kj <= qi + off
        scores = torch.where(cmask[None, None], scores, -1000000000.0)
        p = _softmax(scores, axis=-1)
        ctx = torch.einsum('bhqk,bhkd->bhqd', p, v)
        return torch.einsum('bhqd,hdm->bqm', ctx, w_o)

    def _B_ref(x, w_gate, w_up, w_down):
        g = torch.einsum('bsd,df->bsf', x, w_gate)
        u = torch.einsum('bsd,df->bsf', x, w_up)
        h = _gelu(g) * u
        return torch.einsum('bsf,fd->bsd', h, w_down)
    x = A_x
    mod = (_silu(c) @ w_mod).reshape(c.shape[0], 6, 1, -1)
    sa, ca, ga, sb, cb, gb = (mod[:, 0].clone(), mod[:, 1].clone(), mod[:, 2].clone(), mod[:, 3].clone(), mod[:, 4].clone(), mod[:, 5].clone())
    h = _layernorm(x, axis=-1) * (1 + ca) + sa
    x = x + ga * _A_ref(h, A_c_kv, A_w_q, A_w_uk, A_w_uv, A_w_o)
    h = _layernorm(x, axis=-1) * (1 + cb) + sb
    x = x + gb * _B_ref(h, B_w_gate, B_w_up, B_w_down)
    return x
```

```asm
; @launch grid=(256,1,1) block=(512,1,1) lds=139264

.amdgcn_target "amdgcn-amd-amdhsa--gfx950"
.text
.globl adaLN_cond__compressed_kv_cla__glu_gated_geglu__decode_kernel
.p2align 8
.type adaLN_cond__compressed_kv_cla__glu_gated_geglu__decode_kernel,@function
adaLN_cond__compressed_kv_cla__glu_gated_geglu__decode_kernel:
    s_cmp_ge_u32 s2, 256
    s_cbranch_scc1 L_end
    s_getpc_b64 s[4:5]
L_pc:
    s_lshr_b32 s6, s2, 3
    s_and_b32 s6, s6, 3
    s_lshl_b32 s6, s6, 13
    v_lshl_add_u32 v1, v0, 4, s6
    v_min_u32 v1, L_codeend-L_pc-16, v1
    global_load_dwordx4 v[252:255], v1, s[4:5]
    s_load_dwordx16 s[16:31], s[0:1], 0
    s_load_dwordx8 s[32:39], s[0:1], 64
    s_load_dwordx4 s[40:43], s[0:1], 96
    s_load_dwordx2 s[44:45], s[0:1], 112
    v_and_b32 v1, 63, v0
    v_lshrrev_b32 v2, 6, v0
    s_mov_b32 s72, 0x05040100
    s_mov_b32 s73, 0x07060302
    v_readfirstlane_b32 s3, v2
    v_and_b32 v2, 15, v1
    v_lshrrev_b32 v3, 4, v1
    v_mov_b32 v4, -1
    v_mov_b32 v5, -1
    v_mov_b32 v6, -1
    v_mov_b32 v7, -1
    s_mov_b32 s74, 200000
    s_mov_b32 s46, 0xff00ff00
    s_mov_b32 s47, 0xff00ff00
    v_lshlrev_b32 v8, 4, v1
    v_lshlrev_b32 v9, 4, v2
    v_lshlrev_b32 v13, 2, v1
    s_waitcnt lgkmcnt(0)
    s_mov_b32 s48, s44
    s_and_b32 s49, s45, 0xffff
    s_mov_b32 s50, 8388608
    s_mov_b32 s51, 0x20000
    s_mov_b32 s52, s42
    s_and_b32 s53, s43, 0xffff
    s_mov_b32 s54, 256
    s_mov_b32 s55, 0x20000
    s_cmp_lt_u32 s2, 128
    s_cbranch_scc1 L_roleE
    s_sub_u32 s4, s2, 128
    s_lshr_b32 s5, s4, 5
    s_and_b32 s6, s4, 31
    s_mov_b32 s56, s18
    s_and_b32 s57, s19, 0xffff
    s_mov_b32 s58, 16777216
    s_mov_b32 s59, 0x20000
    s_lshl_b32 s7, s5, 20
    s_lshl_b32 s8, s6, 10
    s_add_u32 s7, s7, s8
    s_add_u32 s7, s7, 1048576
    s_lshl_b32 s12, s5, 17
    s_lshl_b32 s8, s6, 7
    s_add_u32 s12, s12, s8
    s_add_u32 s12, s12, 5242880
    v_and_b32 v10, 7, v2
    v_lshlrev_b32 v10, 4, v10
    s_cmp_lg_u32 s3, 6
    s_cbranch_scc1 L_1
    s_lshl_b32 s8, s4, 10
    s_add_u32 s8, s8, 32768
    s_lshl_b32 s9, s4, 8
    s_add_u32 s9, s9, 163840
    buffer_store_dwordx4 v[4:7], v8, s[48:51], s8 offen sc1
    buffer_store_dwordx4 v[4:7], v9, s[48:51], s9 offen sc1
    buffer_load_dwordx2 v[20:21], off, s[52:55], 0 offset:0 sc1
L_1:
    s_cmp_ge_u32 s4, 127
    s_cbranch_scc1 Lnone_4
    s_cmp_ge_u32 s4, 100
    s_cbranch_scc1 LS6c_3
    s_cmp_ge_u32 s4, 60
    s_cbranch_scc1 LS5c_2
    s_movk_i32 s10, 7680
    v_mul_lo_u32 v11, s10, v3
    v_add_u32 v10, v10, v11
    s_lshl_b32 s13, s4, 7
    s_add_u32 s13, s13, 0
    s_cmp_lg_u32 s3, 6
    s_cbranch_scc1 L_7
    buffer_store_dwordx4 v[4:7], v10, s[48:51], s13 offen sc1
L_7:
    s_mul_i32 s14, s4, 205
    s_lshr_b32 s14, s14, 11
    s_mul_i32 s15, s14, 10
    s_sub_u32 s15, s4, s15
    s_lshl_b32 s15, s15, 7
    s_mov_b32 s76, 0
    s_mov_b32 s60, s38
    s_and_b32 s61, s39, 0xffff
    s_mov_b32 s62, 4915200
    s_mov_b32 s63, 0x20000
    s_mov_b32 s64, s36
    s_and_b32 s65, s37, 0xffff
    s_mov_b32 s66, 5120
    s_mov_b32 s67, 0x20000
    s_cmp_ge_u32 s4, 20
    s_cbranch_scc1 LS0o_8
    v_bfe_u32 v14, v1, 3, 1
    v_lshlrev_b32 v14, 2, v14
    v_add_u32 v14, v14, v3
    s_mov_b32 s10, 61440
    v_mul_lo_u32 v12, s10, v14
    v_and_b32 v14, 7, v1
    v_lshl_add_u32 v12, v14, 4, v12
    s_mul_i32 s8, s3, 491520
    s_lshl_b32 s9, s4, 7
    s_add_u32 s8, s8, s9
    v_bfe_u32 v15, v1, 2, 2
    s_movk_i32 s10, 1280
    v_mul_lo_u32 v15, v15, s10
    v_and_b32 v14, 1, v1
    v_lshl_add_u32 v15, v14, 6, v15
    v_lshl_add_u32 v15, v3, 4, v15
    s_lshl_b32 s11, s3, 7
    buffer_load_dwordx4 v[176:179], v15, s[64:67], s11 offen
    buffer_load_dwordx4 v[180:183], v15, s[64:67], s11 offen offset:1024
    s_cmp_lg_u32 s3, 7
    s_cbranch_scc1 L_9
    s_mov_b32 s68, s16
    s_and_b32 s69, s17, 0xffff
    s_mov_b32 s70, 5120
    s_mov_b32 s71, 0x20000
    s_sub_u32 s77, s4, 10
    s_cmp_lt_u32 s4, 10
    s_cselect_b32 s77, s4, s77
    s_lshl_b32 s77, s77, 7
    s_movk_i32 s10, 1280
    v_mul_lo_u32 v16, s10, v3
    s_movk_i32 s10, 80
    v_mul_lo_u32 v14, s10, v2
    v_add_u32 v14, v14, v16
    buffer_load_dwordx4 v[128:131], v14, s[68:71], 0 offen offset:0
    buffer_load_dwordx4 v[132:135], v14, s[68:71], 0 offen offset:16
    buffer_load_dwordx4 v[136:139], v14, s[68:71], 0 offen offset:32
    buffer_load_dwordx4 v[140:143], v14, s[68:71], 0 offen offset:48
    buffer_load_dwordx4 v[144:147], v14, s[68:71], 0 offen offset:64
    s_movk_i32 s10, 1280
    v_mul_lo_u32 v14, s10, v3
    v_and_b32 v15, 7, v2
    v_lshl_add_u32 v14, v15, 4, v14
    v_lshrrev_b32 v15, 3, v2
    v_lshl_add_u32 v14, v15, 3, v14
    buffer_load_dwordx2 v[148:149], v14, s[68:71], s77 offen
L_9:
    s_add_u32 s9, s8, 0
    buffer_load_dwordx4 v[64:67], v12, s[60:63], s9 offen nt
    s_add_u32 s9, s8, 7680
    buffer_load_dwordx4 v[68:71], v12, s[60:63], s9 offen nt
    s_add_u32 s9, s8, 15360
    buffer_load_dwordx4 v[72:75], v12, s[60:63], s9 offen nt
    s_add_u32 s9, s8, 23040
    buffer_load_dwordx4 v[76:79], v12, s[60:63], s9 offen nt
    s_add_u32 s9, s8, 30720
    buffer_load_dwordx4 v[80:83], v12, s[60:63], s9 offen nt
    s_add_u32 s9, s8, 38400
    buffer_load_dwordx4 v[84:87], v12, s[60:63], s9 offen nt
    s_add_u32 s9, s8, 46080
    buffer_load_dwordx4 v[88:91], v12, s[60:63], s9 offen nt
    s_add_u32 s9, s8, 53760
    buffer_load_dwordx4 v[92:95], v12, s[60:63], s9 offen nt
    s_cmp_ge_u32 s3, 2
    s_cbranch_scc1 L_10
    s_add_u32 s9, s8, 3932160
    buffer_load_dwordx4 v[96:99], v12, s[60:63], s9 offen nt
    s_add_u32 s9, s8, 3939840
    buffer_load_dwordx4 v[100:103], v12, s[60:63], s9 offen nt
    s_add_u32 s9, s8, 3947520
    buffer_load_dwordx4 v[104:107], v12, s[60:63], s9 offen nt
    s_add_u32 s9, s8, 3955200
    buffer_load_dwordx4 v[108:111], v12, s[60:63], s9 offen nt
    s_add_u32 s9, s8, 3962880
    buffer_load_dwordx4 v[112:115], v12, s[60:63], s9 offen nt
    s_add_u32 s9, s8, 3970560
    buffer_load_dwordx4 v[116:119], v12, s[60:63], s9 offen nt
    s_add_u32 s9, s8, 3978240
    buffer_load_dwordx4 v[120:123], v12, s[60:63], s9 offen nt
    s_add_u32 s9, s8, 3985920
    buffer_load_dwordx4 v[124:127], v12, s[60:63], s9 offen nt
    buffer_load_dwordx2 v[20:21], off, s[52:55], 0 offset:0 sc1
    s_waitcnt vmcnt(17)
    s_branch L_11
L_10:
    buffer_load_dwordx2 v[20:21], off, s[52:55], 0 offset:0 sc1
    s_waitcnt vmcnt(9)
L_11:
    s_mov_b32 s10, 0xbfb8aa3b
    v_lshlrev_b32 v192, 16, v176
    v_and_b32 v193, 0xffff0000, v176
    v_lshlrev_b32 v194, 16, v177
    v_and_b32 v195, 0xffff0000, v177
    v_lshlrev_b32 v196, 16, v178
    v_and_b32 v197, 0xffff0000, v178
    v_lshlrev_b32 v198, 16, v179
    v_and_b32 v199, 0xffff0000, v179
    v_lshlrev_b32 v200, 16, v180
    v_and_b32 v201, 0xffff0000, v180
    v_lshlrev_b32 v202, 16, v181
    v_and_b32 v203, 0xffff0000, v181
    v_lshlrev_b32 v204, 16, v182
    v_and_b32 v205, 0xffff0000, v182
    v_lshlrev_b32 v206, 16, v183
    v_and_b32 v207, 0xffff0000, v183
    v_mul_f32 v208, s10, v192
    v_mul_f32 v209, s10, v193
    v_mul_f32 v210, s10, v194
    v_mul_f32 v211, s10, v195
    v_mul_f32 v212, s10, v196
    v_mul_f32 v213, s10, v197
    v_mul_f32 v214, s10, v198
    v_mul_f32 v215, s10, v199
    v_mul_f32 v216, s10, v200
    v_mul_f32 v217, s10, v201
    v_mul_f32 v218, s10, v202
    v_mul_f32 v219, s10, v203
    v_mul_f32 v220, s10, v204
    v_mul_f32 v221, s10, v205
    v_mul_f32 v222, s10, v206
    v_mul_f32 v223, s10, v207
    v_exp_f32 v208, v208
    v_exp_f32 v209, v209
    v_exp_f32 v210, v210
    v_exp_f32 v211, v211
    v_exp_f32 v212, v212
    v_exp_f32 v213, v213
    v_exp_f32 v214, v214
    v_exp_f32 v215, v215
    v_exp_f32 v216, v216
    v_exp_f32 v217, v217
    v_exp_f32 v218, v218
    v_exp_f32 v219, v219
    v_exp_f32 v220, v220
    v_exp_f32 v221, v221
    v_exp_f32 v222, v222
    v_exp_f32 v223, v223
    v_add_f32 v208, 1.0, v208
    v_add_f32 v209, 1.0, v209
    v_add_f32 v210, 1.0, v210
    v_add_f32 v211, 1.0, v211
    v_add_f32 v212, 1.0, v212
    v_add_f32 v213, 1.0, v213
    v_add_f32 v214, 1.0, v214
    v_add_f32 v215, 1.0, v215
    v_add_f32 v216, 1.0, v216
    v_add_f32 v217, 1.0, v217
    v_add_f32 v218, 1.0, v218
    v_add_f32 v219, 1.0, v219
    v_add_f32 v220, 1.0, v220
    v_add_f32 v221, 1.0, v221
    v_add_f32 v222, 1.0, v222
    v_add_f32 v223, 1.0, v223
    v_rcp_f32 v208, v208
    v_rcp_f32 v209, v209
    v_rcp_f32 v210, v210
    v_rcp_f32 v211, v211
    v_rcp_f32 v212, v212
    v_rcp_f32 v213, v213
    v_rcp_f32 v214, v214
    v_rcp_f32 v215, v215
    v_rcp_f32 v216, v216
    v_rcp_f32 v217, v217
    v_rcp_f32 v218, v218
    v_rcp_f32 v219, v219
    v_rcp_f32 v220, v220
    v_rcp_f32 v221, v221
    v_rcp_f32 v222, v222
    v_rcp_f32 v223, v223
    v_mul_f32 v192, v192, v208
    v_mul_f32 v193, v193, v209
    v_mul_f32 v194, v194, v210
    v_mul_f32 v195, v195, v211
    v_mul_f32 v196, v196, v212
    v_mul_f32 v197, v197, v213
    v_mul_f32 v198, v198, v214
    v_mul_f32 v199, v199, v215
    v_mul_f32 v200, v200, v216
    v_mul_f32 v201, v201, v217
    v_mul_f32 v202, v202, v218
    v_mul_f32 v203, v203, v219
    v_mul_f32 v204, v204, v220
    v_mul_f32 v205, v205, v221
    v_mul_f32 v206, v206, v222
    v_mul_f32 v207, v207, v223
    v_cvt_pk_bf16_f32 v176, v192, v193
    v_cvt_pk_bf16_f32 v177, v194, v195
    v_cvt_pk_bf16_f32 v178, v196, v197
    v_cvt_pk_bf16_f32 v179, v198, v199
    v_cvt_pk_bf16_f32 v180, v200, v201
    v_cvt_pk_bf16_f32 v181, v202, v203
    v_cvt_pk_bf16_f32 v182, v204, v205
    v_cvt_pk_bf16_f32 v183, v206, v207
    s_cmp_lg_u32 s3, 7
    s_cbranch_scc1 L_12
    v_lshlrev_b32 v192, 16, v128
    v_and_b32 v193, 0xffff0000, v128
    v_lshlrev_b32 v194, 16, v129
    v_and_b32 v195, 0xffff0000, v129
    v_lshlrev_b32 v196, 16, v130
    v_and_b32 v197, 0xffff0000, v130
    v_lshlrev_b32 v198, 16, v131
    v_and_b32 v199, 0xffff0000, v131
    v_lshlrev_b32 v200, 16, v132
    v_and_b32 v201, 0xffff0000, v132
    v_lshlrev_b32 v202, 16, v133
    v_and_b32 v203, 0xffff0000, v133
    v_lshlrev_b32 v204, 16, v134
    v_and_b32 v205, 0xffff0000, v134
    v_lshlrev_b32 v206, 16, v135
    v_and_b32 v207, 0xffff0000, v135
    v_lshlrev_b32 v208, 16, v136
    v_and_b32 v209, 0xffff0000, v136
    v_lshlrev_b32 v210, 16, v137
    v_and_b32 v211, 0xffff0000, v137
    v_lshlrev_b32 v212, 16, v138
    v_and_b32 v213, 0xffff0000, v138
    v_lshlrev_b32 v214, 16, v139
    v_and_b32 v215, 0xffff0000, v139
    v_lshlrev_b32 v216, 16, v140
    v_and_b32 v217, 0xffff0000, v140
    v_lshlrev_b32 v218, 16, v141
    v_and_b32 v219, 0xffff0000, v141
    v_lshlrev_b32 v220, 16, v142
    v_and_b32 v221, 0xffff0000, v142
    v_lshlrev_b32 v222, 16, v143
    v_and_b32 v223, 0xffff0000, v143
    v_lshlrev_b32 v224, 16, v144
    v_and_b32 v225, 0xffff0000, v144
    v_lshlrev_b32 v226, 16, v145
    v_and_b32 v227, 0xffff0000, v145
    v_lshlrev_b32 v228, 16, v146
    v_and_b32 v229, 0xffff0000, v146
    v_lshlrev_b32 v230, 16, v147
    v_and_b32 v231, 0xffff0000, v147
    v_pk_add_f32 v[232:233], v[192:193], v[194:195]
    v_pk_add_f32 v[234:235], v[196:197], v[198:199]
    v_pk_add_f32 v[236:237], v[200:201], v[202:203]
    v_pk_add_f32 v[238:239], v[204:205], v[206:207]
    v_pk_add_f32 v[240:241], v[208:209], v[210:211]
    v_pk_add_f32 v[242:243], v[212:213], v[214:215]
    v_pk_add_f32 v[244:245], v[216:217], v[218:219]
    v_pk_add_f32 v[246:247], v[220:221], v[222:223]
    v_pk_add_f32 v[248:249], v[224:225], v[226:227]
    v_pk_add_f32 v[250:251], v[228:229], v[230:231]
    v_pk_add_f32 v[232:233], v[232:233], v[242:243]
    v_pk_add_f32 v[234:235], v[234:235], v[244:245]
    v_pk_add_f32 v[236:237], v[236:237], v[246:247]
    v_pk_add_f32 v[238:239], v[238:239], v[248:249]
    v_pk_add_f32 v[240:241], v[240:241], v[250:251]
    v_pk_add_f32 v[232:233], v[232:233], v[234:235]
    v_pk_add_f32 v[236:237], v[236:237], v[238:239]
    v_pk_add_f32 v[232:233], v[232:233], v[236:237]
    v_pk_add_f32 v[232:233], v[232:233], v[240:241]
    v_add_f32 v232, v232, v233
    s_nop 1
    v_add_f32_dpp v232, v232, v232 quad_perm:[1,0,3,2] row_mask:0xf bank_mask:0xf
    s_nop 1
    v_add_f32_dpp v232, v232, v232 quad_perm:[2,3,0,1] row_mask:0xf bank_mask:0xf
    s_nop 1
    v_add_f32_dpp v232, v232, v232 row_half_mirror row_mask:0xf bank_mask:0xf
    s_nop 1
    v_add_f32_dpp v232, v232, v232 row_mirror row_mask:0xf bank_mask:0xf
    s_mov_b32 s10, 0xbacccccd
    v_mul_f32 v232, s10, v232
    v_mov_b32 v233, v232
    v_pk_add_f32 v[192:193], v[192:193], v[232:233]
    v_pk_add_f32 v[194:195], v[194:195], v[232:233]
    v_pk_add_f32 v[196:197], v[196:197], v[232:233]
    v_pk_add_f32 v[198:199], v[198:199], v[232:233]
    v_pk_add_f32 v[200:201], v[200:201], v[232:233]
    v_pk_add_f32 v[202:203], v[202:203], v[232:233]
    v_pk_add_f32 v[204:205], v[204:205], v[232:233]
    v_pk_add_f32 v[206:207], v[206:207], v[232:233]
    v_pk_add_f32 v[208:209], v[208:209], v[232:233]
    v_pk_add_f32 v[210:211], v[210:211], v[232:233]
    v_pk_add_f32 v[212:213], v[212:213], v[232:233]
    v_pk_add_f32 v[214:215], v[214:215], v[232:233]
    v_pk_add_f32 v[216:217], v[216:217], v[232:233]
    v_pk_add_f32 v[218:219], v[218:219], v[232:233]
    v_pk_add_f32 v[220:221], v[220:221], v[232:233]
    v_pk_add_f32 v[222:223], v[222:223], v[232:233]
    v_pk_add_f32 v[224:225], v[224:225], v[232:233]
    v_pk_add_f32 v[226:227], v[226:227], v[232:233]
    v_pk_add_f32 v[228:229], v[228:229], v[232:233]
    v_pk_add_f32 v[230:231], v[230:231], v[232:233]
    v_pk_mul_f32 v[234:235], v[192:193], v[192:193]
    v_pk_mul_f32 v[236:237], v[194:195], v[194:195]
    v_pk_mul_f32 v[238:239], v[196:197], v[196:197]
    v_pk_mul_f32 v[240:241], v[198:199], v[198:199]
    v_pk_fma_f32 v[234:235], v[200:201], v[200:201], v[234:235]
    v_pk_fma_f32 v[236:237], v[202:203], v[202:203], v[236:237]
    v_pk_fma_f32 v[238:239], v[204:205], v[204:205], v[238:239]
    v_pk_fma_f32 v[240:241], v[206:207], v[206:207], v[240:241]
    v_pk_fma_f32 v[234:235], v[208:209], v[208:209], v[234:235]
    v_pk_fma_f32 v[236:237], v[210:211], v[210:211], v[236:237]
    v_pk_fma_f32 v[238:239], v[212:213], v[212:213], v[238:239]
    v_pk_fma_f32 v[240:241], v[214:215], v[214:215], v[240:241]
    v_pk_fma_f32 v[234:235], v[216:217], v[216:217], v[234:235]
    v_pk_fma_f32 v[236:237], v[218:219], v[218:219], v[236:237]
    v_pk_fma_f32 v[238:239], v[220:221], v[220:221], v[238:239]
    v_pk_fma_f32 v[240:241], v[222:223], v[222:223], v[240:241]
    v_pk_fma_f32 v[234:235], v[224:225], v[224:225], v[234:235]
    v_pk_fma_f32 v[236:237], v[226:227], v[226:227], v[236:237]
    v_pk_fma_f32 v[238:239], v[228:229], v[228:229], v[238:239]
    v_pk_fma_f32 v[240:241], v[230:231], v[230:231], v[240:241]
    v_pk_add_f32 v[234:235], v[234:235], v[236:237]
    v_pk_add_f32 v[238:239], v[238:239], v[240:241]
    v_pk_add_f32 v[234:235], v[234:235], v[238:239]
    v_add_f32 v234, v234, v235
    s_nop 1
    v_add_f32_dpp v234, v234, v234 quad_perm:[1,0,3,2] row_mask:0xf bank_mask:0xf
    s_nop 1
    v_add_f32_dpp v234, v234, v234 quad_perm:[2,3,0,1] row_mask:0xf bank_mask:0xf
    s_nop 1
    v_add_f32_dpp v234, v234, v234 row_half_mirror row_mask:0xf bank_mask:0xf
    s_nop 1
    v_add_f32_dpp v234, v234, v234 row_mirror row_mask:0xf bank_mask:0xf
    s_mov_b32 s10, 0x3acccccd
    s_mov_b32 s11, 0x3727c5ac
    v_mov_b32 v235, s11
    v_fmac_f32 v235, s10, v234
    v_rsq_f32 v235, v235
    v_lshlrev_b32 v150, 16, v148
    v_and_b32 v151, 0xffff0000, v148
    v_lshlrev_b32 v152, 16, v149
    v_and_b32 v153, 0xffff0000, v149
    v_add_f32 v150, v150, v232
    v_add_f32 v151, v151, v232
    v_add_f32 v152, v152, v232
    v_add_f32 v153, v153, v232
    v_mul_f32 v150, v150, v235
    v_mul_f32 v151, v151, v235
    v_mul_f32 v152, v152, v235
    v_mul_f32 v153, v153, v235
    s_cmp_ge_u32 s4, 10
    s_cbranch_scc1 L_13
    v_mov_b32 v150, 1.0
    v_mov_b32 v154, 0
    v_mov_b32 v151, 1.0
    v_mov_b32 v155, 0
    v_mov_b32 v152, 1.0
    v_mov_b32 v156, 0
    v_mov_b32 v153, 1.0
    v_mov_b32 v157, 0
    s_branch L_14
L_13:
    v_mov_b32 v154, v150
    v_mov_b32 v155, v151
    v_mov_b32 v156, v152
    v_mov_b32 v157, v153
L_14:
    ds_write_b128 v8, v[150:153] offset:41984
    ds_write_b128 v8, v[154:157] offset:43008
L_12:
    s_lshl_b32 s11, s3, 10
    s_add_u32 s11, s11, 32768
    v_add_u32 v17, s11, v8
    s_movk_i32 s10, 2560
    v_mul_lo_u32 v12, s10, v3
    v_and_b32 v15, 7, v2
    v_lshl_add_u32 v12, v15, 4, v12
    v_lshrrev_b32 v15, 3, v2
    v_lshl_add_u32 v12, v15, 3, v12
    s_lshl_b32 s66, s4, 7
    s_add_u32 s66, s66, 524288
    s_waitcnt vmcnt(0)
    s_cmp_lg_u32 s3, 6
    s_cbranch_scc1 L_15
Lnn_16:
    v_readfirstlane_b32 s78, v20
    v_readfirstlane_b32 s79, v21
    s_cmp_lg_u32 s78, 0
    s_cbranch_scc1 Lnn_17
    s_sub_u32 s74, s74, 1
    s_cbranch_scc1 L_fail
    s_sleep 4
    buffer_load_dwordx2 v[20:21], off, s[52:55], 0 offset:0 sc1
    s_waitcnt vmcnt(0)
    s_branch Lnn_16
Lnn_17:
    v_mov_b32 v14, s78
    v_mov_b32 v15, s79
    s_lshl_b32 s10, s4, 6
    s_add_u32 s10, s10, 458752
    s_mov_b64 exec, 1
    buffer_store_dwordx2 v[14:15], off, s[48:51], s10 sc1
    s_mov_b64 exec, -1
L_15:
    v_perm_b32 v192, v68, v64, s72
    v_perm_b32 v193, v76, v72, s72
    v_perm_b32 v194, v84, v80, s72
    v_perm_b32 v195, v92, v88, s72
    v_perm_b32 v196, v68, v64, s73
    v_perm_b32 v197, v76, v72, s73
    v_perm_b32 v198, v84, v80, s73
    v_perm_b32 v199, v92, v88, s73
    v_perm_b32 v200, v69, v65, s72
    v_perm_b32 v201, v77, v73, s72
    v_perm_b32 v202, v85, v81, s72
    v_perm_b32 v203, v93, v89, s72
    v_perm_b32 v204, v69, v65, s73
    v_perm_b32 v205, v77, v73, s73
    v_perm_b32 v206, v85, v81, s73
    v_perm_b32 v207, v93, v89, s73
    v_perm_b32 v208, v70, v66, s72
    v_perm_b32 v209, v78, v74, s72
    v_perm_b32 v210, v86, v82, s72
    v_perm_b32 v211, v94, v90, s72
    v_perm_b32 v212, v70, v66, s73
    v_perm_b32 v213, v78, v74, s73
    v_perm_b32 v214, v86, v82, s73
    v_perm_b32 v215, v94, v90, s73
    v_perm_b32 v216, v71, v67, s72
    v_perm_b32 v217, v79, v75, s72
    v_perm_b32 v218, v87, v83, s72
    v_perm_b32 v219, v95, v91, s72
    v_perm_b32 v220, v71, v67, s73
    v_perm_b32 v221, v79, v75, s73
    v_perm_b32 v222, v87, v83, s73
    v_perm_b32 v223, v95, v91, s73
    v_mfma_f32_16x16x32_bf16 v[224:227], v[176:179], v[192:195], 0
    v_mfma_f32_16x16x32_bf16 v[228:231], v[176:179], v[196:199], 0
    v_mfma_f32_16x16x32_bf16 v[232:235], v[176:179], v[200:203], 0
    v_mfma_f32_16x16x32_bf16 v[236:239], v[176:179], v[204:207], 0
    v_mfma_f32_16x16x32_bf16 v[240:243], v[176:179], v[208:211], 0
    v_mfma_f32_16x16x32_bf16 v[244:247], v[176:179], v[212:215], 0
    v_mfma_f32_16x16x32_bf16 v[248:251], v[176:179], v[216:219], 0
    v_mfma_f32_16x16x32_bf16 v[252:255], v[176:179], v[220:223], 0
    s_cmp_ge_u32 s3, 2
    s_cbranch_scc1 L_18
    v_perm_b32 v64, v100, v96, s72
    v_perm_b32 v65, v108, v104, s72
    v_perm_b32 v66, v116, v112, s72
    v_perm_b32 v67, v124, v120, s72
    v_perm_b32 v68, v100, v96, s73
    v_perm_b32 v69, v108, v104, s73
    v_perm_b32 v70, v116, v112, s73
    v_perm_b32 v71, v124, v120, s73
    v_perm_b32 v72, v101, v97, s72
    v_perm_b32 v73, v109, v105, s72
    v_perm_b32 v74, v117, v113, s72
    v_perm_b32 v75, v125, v121, s72
    v_perm_b32 v76, v101, v97, s73
    v_perm_b32 v77, v109, v105, s73
    v_perm_b32 v78, v117, v113, s73
    v_perm_b32 v79, v125, v121, s73
    v_perm_b32 v80, v102, v98, s72
    v_perm_b32 v81, v110, v106, s72
    v_perm_b32 v82, v118, v114, s72
    v_perm_b32 v83, v126, v122, s72
    v_perm_b32 v84, v102, v98, s73
    v_perm_b32 v85, v110, v106, s73
    v_perm_b32 v86, v118, v114, s73
    v_perm_b32 v87, v126, v122, s73
    v_perm_b32 v88, v103, v99, s72
    v_perm_b32 v89, v111, v107, s72
    v_perm_b32 v90, v119, v115, s72
    v_perm_b32 v91, v127, v123, s72
    v_perm_b32 v92, v103, v99, s73
    v_perm_b32 v93, v111, v107, s73
    v_perm_b32 v94, v119, v115, s73
    v_perm_b32 v95, v127, v123, s73
    s_nop 1
    v_mfma_f32_16x16x32_bf16 v[224:227], v[180:183], v[64:67], v[224:227]
    v_mfma_f32_16x16x32_bf16 v[228:231], v[180:183], v[68:71], v[228:231]
    v_mfma_f32_16x16x32_bf16 v[232:235], v[180:183], v[72:75], v[232:235]
    v_mfma_f32_16x16x32_bf16 v[236:239], v[180:183], v[76:79], v[236:239]
    v_mfma_f32_16x16x32_bf16 v[240:243], v[180:183], v[80:83], v[240:243]
    v_mfma_f32_16x16x32_bf16 v[244:247], v[180:183], v[84:87], v[244:247]
    v_mfma_f32_16x16x32_bf16 v[248:251], v[180:183], v[88:91], v[248:251]
    v_mfma_f32_16x16x32_bf16 v[252:255], v[180:183], v[92:95], v[252:255]
L_18:
    s_nop 7
    v_cndmask_b32 v192, v224, v241, s[46:47]
    v_cndmask_b32 v196, v240, v225, s[46:47]
    v_cndmask_b32 v193, v228, v245, s[46:47]
    v_cndmask_b32 v197, v244, v229, s[46:47]
    v_cndmask_b32 v194, v232, v249, s[46:47]
    v_cndmask_b32 v198, v248, v233, s[46:47]
    v_cndmask_b32 v195, v236, v253, s[46:47]
    v_cndmask_b32 v199, v252, v237, s[46:47]
    s_nop 0
    v_add_f32_dpp v192, v196, v192 row_ror:8 row_mask:0xf bank_mask:0xf
    v_add_f32_dpp v193, v197, v193 row_ror:8 row_mask:0xf bank_mask:0xf
    v_add_f32_dpp v194, v198, v194 row_ror:8 row_mask:0xf bank_mask:0xf
    v_add_f32_dpp v195, v199, v195 row_ror:8 row_mask:0xf bank_mask:0xf
    ds_write_b128 v17, v[192:195]
    s_waitcnt lgkmcnt(0)
    s_barrier
    s_cmp_lg_u32 s3, 0
    s_cbranch_scc1 L_19
    ds_read_b128 v[192:195], v8 offset:32768
    ds_read_b128 v[196:199], v8 offset:33792
    ds_read_b128 v[200:203], v8 offset:34816
    ds_read_b128 v[204:207], v8 offset:35840
    ds_read_b128 v[208:211], v8 offset:36864
    ds_read_b128 v[212:215], v8 offset:37888
    ds_read_b128 v[216:219], v8 offset:38912
    ds_read_b128 v[220:223], v8 offset:39936
    ds_read_b128 v[224:227], v8 offset:41984
    ds_read_b128 v[228:231], v8 offset:43008
Lnn_20:
    v_readfirstlane_b32 s78, v20
    v_readfirstlane_b32 s79, v21
    s_cmp_lg_u32 s78, 0
    s_cbranch_scc1 Lnn_21
    s_sub_u32 s74, s74, 1
    s_cbranch_scc1 L_fail
    s_sleep 4
    buffer_load_dwordx2 v[20:21], off, s[52:55], 0 offset:0 sc1
    s_waitcnt vmcnt(0)
    s_branch Lnn_20
Lnn_21:
    s_waitcnt lgkmcnt(0)
    v_pk_add_f32 v[192:193], v[192:193], v[208:209]
    v_pk_add_f32 v[194:195], v[194:195], v[210:211]
    v_pk_add_f32 v[196:197], v[196:197], v[212:213]
    v_pk_add_f32 v[198:199], v[198:199], v[214:215]
    v_pk_add_f32 v[200:201], v[200:201], v[216:217]
    v_pk_add_f32 v[202:203], v[202:203], v[218:219]
    v_pk_add_f32 v[204:205], v[204:205], v[220:221]
    v_pk_add_f32 v[206:207], v[206:207], v[222:223]
    v_pk_add_f32 v[192:193], v[192:193], v[200:201]
    v_pk_add_f32 v[194:195], v[194:195], v[202:203]
    v_pk_add_f32 v[196:197], v[196:197], v[204:205]
    v_pk_add_f32 v[198:199], v[198:199], v[206:207]
    v_pk_add_f32 v[192:193], v[192:193], v[196:197]
    v_pk_add_f32 v[194:195], v[194:195], v[198:199]
    v_fma_f32 v192, v192, v224, v228
    v_fma_f32 v193, v193, v225, v229
    v_fma_f32 v194, v194, v226, v230
    v_fma_f32 v195, v195, v227, v231
    v_cvt_pk_bf16_f32 v192, v192, v193
    v_cvt_pk_bf16_f32 v193, v194, v195
    v_xor_b32 v194, s78, v192
    v_xor_b32 v195, s78, v193
    s_add_u32 s11, s66, 0
    s_add_u32 s9, s66, 10240
    buffer_store_dwordx2 v[192:193], v12, s[48:51], s11 offen sc1
    buffer_store_dwordx2 v[194:195], v12, s[48:51], s9 offen sc1
    s_add_u32 s11, s66, 20480
    s_add_u32 s9, s66, 30720
    buffer_store_dwordx2 v[192:193], v12, s[48:51], s11 offen sc1
    buffer_store_dwordx2 v[194:195], v12, s[48:51], s9 offen sc1
    s_add_u32 s11, s66, 40960
    s_add_u32 s9, s66, 51200
    buffer_store_dwordx2 v[192:193], v12, s[48:51], s11 offen sc1
    buffer_store_dwordx2 v[194:195], v12, s[48:51], s9 offen sc1
    s_add_u32 s11, s66, 61440
    s_add_u32 s9, s66, 71680
    buffer_store_dwordx2 v[192:193], v12, s[48:51], s11 offen sc1
    buffer_store_dwordx2 v[194:195], v12, s[48:51], s9 offen sc1
    s_add_u32 s11, s66, 81920
    s_add_u32 s9, s66, 92160
    buffer_store_dwordx2 v[192:193], v12, s[48:51], s11 offen sc1
    buffer_store_dwordx2 v[194:195], v12, s[48:51], s9 offen sc1
    s_add_u32 s11, s66, 102400
    s_add_u32 s9, s66, 112640
    buffer_store_dwordx2 v[192:193], v12, s[48:51], s11 offen sc1
    buffer_store_dwordx2 v[194:195], v12, s[48:51], s9 offen sc1
    s_add_u32 s11, s66, 122880
    s_add_u32 s9, s66, 133120
    buffer_store_dwordx2 v[192:193], v12, s[48:51], s11 offen sc1
    buffer_store_dwordx2 v[194:195], v12, s[48:51], s9 offen sc1
    s_add_u32 s11, s66, 143360
    s_add_u32 s9, s66, 153600
    buffer_store_dwordx2 v[192:193], v12, s[48:51], s11 offen sc1
    buffer_store_dwordx2 v[194:195], v12, s[48:51], s9 offen sc1
L_19:
    s_barrier
    s_lshl_b32 s8, s5, 12
    s_lshl_b32 s9, s6, 7
    s_add_u32 s8, s8, s9
    s_lshl_b32 s9, s3, 4
    s_add_u32 s8, s8, s9
    s_lshl_b32 s8, s8, 10
    s_lshl_b32 s9, s3, 14
    v_xor_b32 v15, 0, v8
    s_add_u32 m0, s9, 0
    s_add_u32 s10, s8, 0
    buffer_load_dwordx4 v15, s[56:59], s10 offen nt lds
    v_xor_b32 v15, 32, v8
    s_add_u32 m0, s9, 1024
    s_add_u32 s10, s8, 1024
    buffer_load_dwordx4 v15, s[56:59], s10 offen nt lds
    v_xor_b32 v15, 64, v8
    s_add_u32 m0, s9, 2048
    s_add_u32 s10, s8, 2048
    buffer_load_dwordx4 v15, s[56:59], s10 offen nt lds
    v_xor_b32 v15, 96, v8
    s_add_u32 m0, s9, 3072
    s_add_u32 s10, s8, 3072
    buffer_load_dwordx4 v15, s[56:59], s10 offen nt lds
    v_xor_b32 v15, 144, v8
    s_add_u32 m0, s9, 4096
    s_add_u32 s10, s8, 4096
    buffer_load_dwordx4 v15, s[56:59], s10 offen nt lds
    v_xor_b32 v15, 176, v8
    s_add_u32 m0, s9, 5120
    s_add_u32 s10, s8, 5120
    buffer_load_dwordx4 v15, s[56:59], s10 offen nt lds
    v_xor_b32 v15, 208, v8
    s_add_u32 m0, s9, 6144
    s_add_u32 s10, s8, 6144
    buffer_load_dwordx4 v15, s[56:59], s10 offen nt lds
    v_xor_b32 v15, 240, v8
    s_add_u32 m0, s9, 7168
    s_add_u32 s10, s8, 7168
    buffer_load_dwordx4 v15, s[56:59], s10 offen nt lds
    v_xor_b32 v15, 128, v8
    s_add_u32 m0, s9, 8192
    s_add_u32 s10, s8, 8192
    buffer_load_dwordx4 v15, s[56:59], s10 offen nt lds
    v_xor_b32 v15, 160, v8
    s_add_u32 m0, s9, 9216
    s_add_u32 s10, s8, 9216
    buffer_load_dwordx4 v15, s[56:59], s10 offen nt lds
    v_xor_b32 v15, 192, v8
    s_add_u32 m0, s9, 10240
    s_add_u32 s10, s8, 10240
    buffer_load_dwordx4 v15, s[56:59], s10 offen nt lds
    v_xor_b32 v15, 224, v8
    s_add_u32 m0, s9, 11264
    s_add_u32 s10, s8, 11264
    buffer_load_dwordx4 v15, s[56:59], s10 offen nt lds
    v_xor_b32 v15, 16, v8
    s_add_u32 m0, s9, 12288
    s_add_u32 s10, s8, 12288
    buffer_load_dwordx4 v15, s[56:59], s10 offen nt lds
    v_xor_b32 v15, 48, v8
    s_add_u32 m0, s9, 13312
    s_add_u32 s10, s8, 13312
    buffer_load_dwordx4 v15, s[56:59], s10 offen nt lds
    v_xor_b32 v15, 80, v8
    s_add_u32 m0, s9, 14336
    s_add_u32 s10, s8, 14336
    buffer_load_dwordx4 v15, s[56:59], s10 offen nt lds
    v_xor_b32 v15, 112, v8
    s_add_u32 m0, s9, 15360
    s_add_u32 s10, s8, 15360
    buffer_load_dwordx4 v15, s[56:59], s10 offen nt lds
    s_branch LAd_6
LS0o_8:
    s_branch LAc_5
LS5c_2:
    s_sub_u32 s14, s4, 60
    s_mul_i32 s15, s14, 205
    s_lshr_b32 s15, s15, 11
    s_mul_i32 s13, s15, 10
    s_sub_u32 s14, s14, s13
    s_movk_i32 s10, 1280
    v_mul_lo_u32 v11, s10, v3
    v_add_u32 v10, v10, v11
    s_mul_i32 s13, s15, 5120
    s_lshl_b32 s9, s14, 7
    s_add_u32 s13, s13, s9
    s_add_u32 s13, s13, 229376
    s_cmp_lg_u32 s3, 6
    s_cbranch_scc1 L_22
    buffer_store_dwordx4 v[4:7], v10, s[48:51], s13 offen sc1
L_22:
    s_mov_b32 s76, 1
    s_branch LAc_5
LS6c_3:
    s_sub_u32 s14, s4, 100
    s_mul_i32 s13, s14, 5120
    s_add_u32 s13, s13, 262144
    s_cmp_lg_u32 s3, 6
    s_cbranch_scc1 L_23
    s_add_u32 s9, s13, 0
    buffer_store_dwordx4 v[4:7], v8, s[48:51], s9 offen sc1
    s_add_u32 s9, s13, 1024
    buffer_store_dwordx4 v[4:7], v8, s[48:51], s9 offen sc1
    s_add_u32 s9, s13, 2048
    buffer_store_dwordx4 v[4:7], v8, s[48:51], s9 offen sc1
    s_add_u32 s9, s13, 3072
    buffer_store_dwordx4 v[4:7], v8, s[48:51], s9 offen sc1
    s_add_u32 s9, s13, 4096
    buffer_store_dwordx4 v[4:7], v8, s[48:51], s9 offen sc1
L_23:
    s_mov_b32 s76, 2
    s_branch LAc_5
Lnone_4:
    s_mov_b32 s76, 3
LAc_5:
    s_cmp_lg_u32 s3, 6
    s_cbranch_scc1 L_24
    s_waitcnt vmcnt(0)
Lnn_25:
    v_readfirstlane_b32 s78, v20
    v_readfirstlane_b32 s79, v21
    s_cmp_lg_u32 s78, 0
    s_cbranch_scc1 Lnn_26
    s_sub_u32 s74, s74, 1
    s_cbranch_scc1 L_fail
    s_sleep 4
    buffer_load_dwordx2 v[20:21], off, s[52:55], 0 offset:0 sc1
    s_waitcnt vmcnt(0)
    s_branch Lnn_25
Lnn_26:
    v_mov_b32 v14, s78
    v_mov_b32 v15, s79
    s_lshl_b32 s10, s4, 6
    s_add_u32 s10, s10, 458752
    s_mov_b64 exec, 1
    buffer_store_dwordx2 v[14:15], off, s[48:51], s10 sc1
    s_mov_b64 exec, -1
L_24:
    s_barrier
    s_lshl_b32 s8, s5, 12
    s_lshl_b32 s9, s6, 7
    s_add_u32 s8, s8, s9
    s_lshl_b32 s9, s3, 4
    s_add_u32 s8, s8, s9
    s_lshl_b32 s8, s8, 10
    s_lshl_b32 s9, s3, 14
    v_xor_b32 v15, 0, v8
    s_add_u32 m0, s9, 0
    s_add_u32 s10, s8, 0
    buffer_load_dwordx4 v15, s[56:59], s10 offen nt lds
    v_xor_b32 v15, 32, v8
    s_add_u32 m0, s9, 1024
    s_add_u32 s10, s8, 1024
    buffer_load_dwordx4 v15, s[56:59], s10 offen nt lds
    v_xor_b32 v15, 64, v8
    s_add_u32 m0, s9, 2048
    s_add_u32 s10, s8, 2048
    buffer_load_dwordx4 v15, s[56:59], s10 offen nt lds
    v_xor_b32 v15, 96, v8
    s_add_u32 m0, s9, 3072
    s_add_u32 s10, s8, 3072
    buffer_load_dwordx4 v15, s[56:59], s10 offen nt lds
    v_xor_b32 v15, 144, v8
    s_add_u32 m0, s9, 4096
    s_add_u32 s10, s8, 4096
    buffer_load_dwordx4 v15, s[56:59], s10 offen nt lds
    v_xor_b32 v15, 176, v8
    s_add_u32 m0, s9, 5120
    s_add_u32 s10, s8, 5120
    buffer_load_dwordx4 v15, s[56:59], s10 offen nt lds
    v_xor_b32 v15, 208, v8
    s_add_u32 m0, s9, 6144
    s_add_u32 s10, s8, 6144
    buffer_load_dwordx4 v15, s[56:59], s10 offen nt lds
    v_xor_b32 v15, 240, v8
    s_add_u32 m0, s9, 7168
    s_add_u32 s10, s8, 7168
    buffer_load_dwordx4 v15, s[56:59], s10 offen nt lds
    v_xor_b32 v15, 128, v8
    s_add_u32 m0, s9, 8192
    s_add_u32 s10, s8, 8192
    buffer_load_dwordx4 v15, s[56:59], s10 offen nt lds
    v_xor_b32 v15, 160, v8
    s_add_u32 m0, s9, 9216
    s_add_u32 s10, s8, 9216
    buffer_load_dwordx4 v15, s[56:59], s10 offen nt lds
    v_xor_b32 v15, 192, v8
    s_add_u32 m0, s9, 10240
    s_add_u32 s10, s8, 10240
    buffer_load_dwordx4 v15, s[56:59], s10 offen nt lds
    v_xor_b32 v15, 224, v8
    s_add_u32 m0, s9, 11264
    s_add_u32 s10, s8, 11264
    buffer_load_dwordx4 v15, s[56:59], s10 offen nt lds
    v_xor_b32 v15, 16, v8
    s_add_u32 m0, s9, 12288
    s_add_u32 s10, s8, 12288
    buffer_load_dwordx4 v15, s[56:59], s10 offen nt lds
    v_xor_b32 v15, 48, v8
    s_add_u32 m0, s9, 13312
    s_add_u32 s10, s8, 13312
    buffer_load_dwordx4 v15, s[56:59], s10 offen nt lds
    v_xor_b32 v15, 80, v8
    s_add_u32 m0, s9, 14336
    s_add_u32 s10, s8, 14336
    buffer_load_dwordx4 v15, s[56:59], s10 offen nt lds
    v_xor_b32 v15, 112, v8
    s_add_u32 m0, s9, 15360
    s_add_u32 s10, s8, 15360
    buffer_load_dwordx4 v15, s[56:59], s10 offen nt lds
LAd_6:
    v_xor_b32 v18, v3, v2
    v_lshlrev_b32 v18, 4, v18
    v_lshlrev_b32 v19, 10, v2
    v_add_u32 v18, v18, v19
    v_xor_b32 v20, 0, v18
    v_xor_b32 v21, 64, v18
    v_xor_b32 v22, 128, v18
    v_xor_b32 v23, 192, v18
    v_and_b32 v18, 3, v2
    v_lshlrev_b32 v18, 1, v18
    v_bfe_u32 v19, v2, 2, 1
    v_add_u32 v18, v18, v19
    v_bfe_u32 v28, v2, 3, 1
    v_xor_b32 v28, v28, v19
    v_lshl_add_u32 v18, v28, 3, v18
    v_xor_b32 v18, v18, v3
    v_lshlrev_b32 v18, 4, v18
    v_lshl_add_u32 v18, v2, 10, v18
    s_lshl_b32 s9, s3, 14
    v_add_u32 v18, s9, v18
    v_xor_b32 v24, 0, v18
    v_xor_b32 v25, 64, v18
    v_xor_b32 v26, 128, v18
    v_xor_b32 v27, 192, v18
    v_lshrrev_b32 v18, 2, v2
    v_and_b32 v19, 3, v2
    v_lshl_add_u32 v28, v3, 3, v18
    v_lshrrev_b32 v30, 1, v19
    v_lshl_add_u32 v30, v18, 1, v30
    v_and_b32 v29, 1, v3
    s_and_b32 s9, s3, 1
    v_xor_b32 v29, s9, v29
    v_lshl_add_u32 v30, v29, 3, v30
    s_lshr_b32 s9, s3, 1
    s_lshl_b32 s9, s9, 4
    v_add_u32 v30, s9, v30
    v_lshlrev_b32 v30, 4, v30
    v_and_b32 v19, 1, v19
    v_lshl_add_u32 v30, v19, 3, v30
    v_lshl_add_u32 v28, v28, 10, v30
    v_add_u32 v29, 0x10000, v28
    s_cmp_lg_u32 s3, 6
    s_cbranch_scc1 L_27
    v_lshlrev_b32 v30, 6, v1
    s_mov_b32 s10, 458752
    s_mov_b32 s11, 462848
    buffer_load_dwordx2 v[232:233], v30, s[48:51], s10 offen sc1
    buffer_load_dwordx2 v[234:235], v30, s[48:51], s11 offen sc1
L_27:
    s_cmp_lg_u32 s3, 6
    s_cbranch_scc1 L_28
    s_waitcnt vmcnt(2)
    s_branch L_29
L_28:
    s_waitcnt vmcnt(0)
L_29:
    ds_read_b128 v[32:35], v24 offset:0
    ds_read_b128 v[36:39], v25 offset:0
    ds_read_b128 v[40:43], v26 offset:0
    ds_read_b128 v[44:47], v27 offset:0
    ds_read_b128 v[48:51], v24 offset:256
    ds_read_b128 v[52:55], v25 offset:256
    ds_read_b128 v[56:59], v26 offset:256
    ds_read_b128 v[60:63], v27 offset:256
    ds_read_b128 v[64:67], v24 offset:512
    ds_read_b128 v[68:71], v25 offset:512
    ds_read_b128 v[72:75], v26 offset:512
    ds_read_b128 v[76:79], v27 offset:512
    ds_read_b128 v[80:83], v24 offset:768
    ds_read_b128 v[84:87], v25 offset:768
    ds_read_b128 v[88:91], v26 offset:768
    ds_read_b128 v[92:95], v27 offset:768
    s_barrier
    v_xor_b32 v30, 0, v28
    v_xor_b32 v31, 0, v29
    ds_read_b64_tr_b16 v[96:97], v30 offset:0
    ds_read_b64_tr_b16 v[100:101], v30 offset:32768
    ds_read_b64_tr_b16 v[104:105], v31 offset:0
    ds_read_b64_tr_b16 v[108:109], v31 offset:32768
    v_xor_b32 v30, 144, v28
    v_xor_b32 v31, 144, v29
    ds_read_b64_tr_b16 v[98:99], v30 offset:4096
    ds_read_b64_tr_b16 v[102:103], v30 offset:36864
    ds_read_b64_tr_b16 v[106:107], v31 offset:4096
    ds_read_b64_tr_b16 v[110:111], v31 offset:36864
    v_xor_b32 v30, 32, v28
    v_xor_b32 v31, 32, v29
    ds_read_b64_tr_b16 v[112:113], v30 offset:0
    ds_read_b64_tr_b16 v[116:117], v30 offset:32768
    ds_read_b64_tr_b16 v[120:121], v31 offset:0
    ds_read_b64_tr_b16 v[124:125], v31 offset:32768
    v_xor_b32 v30, 176, v28
    v_xor_b32 v31, 176, v29
    ds_read_b64_tr_b16 v[114:115], v30 offset:4096
    ds_read_b64_tr_b16 v[118:119], v30 offset:36864
    ds_read_b64_tr_b16 v[122:123], v31 offset:4096
    ds_read_b64_tr_b16 v[126:127], v31 offset:36864
    v_xor_b32 v30, 64, v28
    v_xor_b32 v31, 64, v29
    ds_read_b64_tr_b16 v[128:129], v30 offset:0
    ds_read_b64_tr_b16 v[132:133], v30 offset:32768
    ds_read_b64_tr_b16 v[136:137], v31 offset:0
    ds_read_b64_tr_b16 v[140:141], v31 offset:32768
    v_xor_b32 v30, 208, v28
    v_xor_b32 v31, 208, v29
    ds_read_b64_tr_b16 v[130:131], v30 offset:4096
    ds_read_b64_tr_b16 v[134:135], v30 offset:36864
    ds_read_b64_tr_b16 v[138:139], v31 offset:4096
    ds_read_b64_tr_b16 v[142:143], v31 offset:36864
    v_xor_b32 v30, 96, v28
    v_xor_b32 v31, 96, v29
    ds_read_b64_tr_b16 v[144:145], v30 offset:0
    ds_read_b64_tr_b16 v[148:149], v30 offset:32768
    ds_read_b64_tr_b16 v[152:153], v31 offset:0
    ds_read_b64_tr_b16 v[156:157], v31 offset:32768
    v_xor_b32 v30, 240, v28
    v_xor_b32 v31, 240, v29
    ds_read_b64_tr_b16 v[146:147], v30 offset:4096
    ds_read_b64_tr_b16 v[150:151], v30 offset:36864
    ds_read_b64_tr_b16 v[154:155], v31 offset:4096
    ds_read_b64_tr_b16 v[158:159], v31 offset:36864
    s_waitcnt vmcnt(0) lgkmcnt(0)
    s_barrier
    s_cmp_lg_u32 s3, 6
    s_cbranch_scc1 L_30
Lcf_31:
    v_xor_b32 v232, s78, v232
    v_xor_b32 v233, s79, v233
    v_xor_b32 v234, s78, v234
    v_xor_b32 v235, s79, v235
    v_or3_b32 v232, v232, v233, v234
    v_or_b32 v232, v232, v235
    v_cmp_ne_u32 vcc, 0, v232
    s_cbranch_vccz Lcf_32
    s_sub_u32 s74, s74, 1
    s_cbranch_scc1 L_fail
    s_sleep 8
    v_lshlrev_b32 v30, 6, v1
    s_mov_b32 s10, 458752
    s_mov_b32 s11, 462848
    buffer_load_dwordx2 v[232:233], v30, s[48:51], s10 offen sc1
    buffer_load_dwordx2 v[234:235], v30, s[48:51], s11 offen sc1
    s_waitcnt vmcnt(0)
    s_branch Lcf_31
Lcf_32:
L_30:
    s_barrier
    s_cmp_lg_u32 s76, 2
    s_cbranch_scc1 L_34
    s_mov_b32 s60, s30
    s_and_b32 s61, s31, 0xffff
    s_mov_b32 s62, 2211840
    s_mov_b32 s63, 0x20000
    v_lshrrev_b32 v30, 3, v1
    s_mov_b32 s10, 3456
    v_mul_lo_u32 v30, v30, s10
    v_and_b32 v31, 7, v1
    v_lshl_add_u32 v30, v31, 4, v30
    s_mul_i32 s8, s3, 276480
    s_lshl_b32 s9, s14, 7
    s_add_u32 s8, s8, s9
    s_mul_i32 s9, s3, 10240
    s_add_u32 s9, s9, 45056
    s_add_u32 m0, s9, 0
    s_add_u32 s10, s8, 0
    buffer_load_dwordx4 v30, s[60:63], s10 offen nt lds
    s_add_u32 m0, s9, 1024
    s_add_u32 s10, s8, 27648
    buffer_load_dwordx4 v30, s[60:63], s10 offen nt lds
    s_add_u32 m0, s9, 2048
    s_add_u32 s10, s8, 55296
    buffer_load_dwordx4 v30, s[60:63], s10 offen nt lds
    s_add_u32 m0, s9, 3072
    s_add_u32 s10, s8, 82944
    buffer_load_dwordx4 v30, s[60:63], s10 offen nt lds
    s_add_u32 m0, s9, 4096
    s_add_u32 s10, s8, 110592
    buffer_load_dwordx4 v30, s[60:63], s10 offen nt lds
    s_add_u32 m0, s9, 5120
    s_add_u32 s10, s8, 138240
    buffer_load_dwordx4 v30, s[60:63], s10 offen nt lds
    s_add_u32 m0, s9, 6144
    s_add_u32 s10, s8, 165888
    buffer_load_dwordx4 v30, s[60:63], s10 offen nt lds
    s_add_u32 m0, s9, 7168
    s_add_u32 s10, s8, 193536
    buffer_load_dwordx4 v30, s[60:63], s10 offen nt lds
    s_add_u32 m0, s9, 8192
    s_add_u32 s10, s8, 221184
    buffer_load_dwordx4 v30, s[60:63], s10 offen nt lds
    s_add_u32 m0, s9, 9216
    s_add_u32 s10, s8, 248832
    buffer_load_dwordx4 v30, s[60:63], s10 offen nt lds
    s_branch L_33
L_34:
    s_cmp_lg_u32 s76, 0
    s_cbranch_scc1 L_33
    s_cmp_lt_u32 s4, 20
    s_cbranch_scc1 L_33
    s_mov_b32 s60, s38
    s_and_b32 s61, s39, 0xffff
    s_mov_b32 s62, 4915200
    s_mov_b32 s63, 0x20000
    v_lshrrev_b32 v30, 3, v1
    s_mov_b32 s10, 7680
    v_mul_lo_u32 v30, v30, s10
    v_and_b32 v31, 7, v1
    v_lshl_add_u32 v30, v31, 4, v30
    s_mul_i32 s8, s3, 614400
    s_lshl_b32 s9, s4, 7
    s_add_u32 s8, s8, s9
    s_mul_i32 s9, s3, 10240
    s_add_u32 s9, s9, 45056
    s_add_u32 m0, s9, 0
    s_add_u32 s10, s8, 0
    buffer_load_dwordx4 v30, s[60:63], s10 offen nt lds
    s_add_u32 m0, s9, 1024
    s_add_u32 s10, s8, 61440
    buffer_load_dwordx4 v30, s[60:63], s10 offen nt lds
    s_add_u32 m0, s9, 2048
    s_add_u32 s10, s8, 122880
    buffer_load_dwordx4 v30, s[60:63], s10 offen nt lds
    s_add_u32 m0, s9, 3072
    s_add_u32 s10, s8, 184320
    buffer_load_dwordx4 v30, s[60:63], s10 offen nt lds
    s_add_u32 m0, s9, 4096
    s_add_u32 s10, s8, 245760
    buffer_load_dwordx4 v30, s[60:63], s10 offen nt lds
    s_add_u32 m0, s9, 5120
    s_add_u32 s10, s8, 307200
    buffer_load_dwordx4 v30, s[60:63], s10 offen nt lds
    s_add_u32 m0, s9, 6144
    s_add_u32 s10, s8, 368640
    buffer_load_dwordx4 v30, s[60:63], s10 offen nt lds
    s_add_u32 m0, s9, 7168
    s_add_u32 s10, s8, 430080
    buffer_load_dwordx4 v30, s[60:63], s10 offen nt lds
    s_add_u32 m0, s9, 8192
    s_add_u32 s10, s8, 491520
    buffer_load_dwordx4 v30, s[60:63], s10 offen nt lds
    s_add_u32 m0, s9, 9216
    s_add_u32 s10, s8, 552960
    buffer_load_dwordx4 v30, s[60:63], s10 offen nt lds
    v_bfe_u32 v30, v1, 2, 2
    s_movk_i32 s10, 1280
    v_mul_lo_u32 v30, v30, s10
    v_and_b32 v31, 1, v1
    v_lshl_add_u32 v30, v31, 6, v30
    v_lshl_add_u32 v30, v3, 4, v30
    s_lshl_b32 s9, s3, 7
    buffer_load_dwordx4 v[4:7], v30, s[64:67], s9 offen
    buffer_load_dwordx4 v[252:255], v30, s[64:67], s9 offen offset:1024
L_33:
    s_lshl_b32 s8, s5, 15
    s_lshl_b32 s9, s3, 12
    s_add_u32 s8, s8, s9
    s_add_u32 s8, s8, 32768
    s_lshl_b32 s9, s3, 2
    s_and_b32 s9, s9, 15
    s_lshl_b32 s9, s9, 4
    v_xor_b32 v18, s9, v8
    s_lshl_b32 s9, s3, 12
    v_add_u32 v18, s9, v18
    v_xor_b32 v14, 0, v18
    v_xor_b32 v15, 16, v18
    v_xor_b32 v16, 32, v18
    v_xor_b32 v17, 48, v18
    buffer_load_dwordx4 v[160:163], v8, s[48:51], s8 offen offset:0 sc1
    buffer_load_dwordx4 v[164:167], v8, s[48:51], s8 offen offset:1024 sc1
    buffer_load_dwordx4 v[168:171], v8, s[48:51], s8 offen offset:2048 sc1
    buffer_load_dwordx4 v[172:175], v8, s[48:51], s8 offen offset:3072 sc1
    s_sleep 4
    buffer_load_dwordx4 v[176:179], v8, s[48:51], s8 offen offset:0 sc1
    buffer_load_dwordx4 v[180:183], v8, s[48:51], s8 offen offset:1024 sc1
    buffer_load_dwordx4 v[184:187], v8, s[48:51], s8 offen offset:2048 sc1
    buffer_load_dwordx4 v[188:191], v8, s[48:51], s8 offen offset:3072 sc1
Lp2_35:
    s_waitcnt vmcnt(4)
    v_max3_u32 v18, v160, v161, v162
    v_max3_u32 v18, v18, v163, v164
    v_max3_u32 v18, v18, v165, v166
    v_max3_u32 v18, v18, v167, v168
    v_max3_u32 v18, v18, v169, v170
    v_max3_u32 v18, v18, v171, v172
    v_max3_u32 v18, v18, v173, v174
    v_max_u32 v18, v18, v175
    v_cmp_eq_u32 vcc, -1, v18
    s_cbranch_vccz Lp2_36
    buffer_load_dwordx4 v[160:163], v8, s[48:51], s8 offen offset:0 sc1
    buffer_load_dwordx4 v[164:167], v8, s[48:51], s8 offen offset:1024 sc1
    buffer_load_dwordx4 v[168:171], v8, s[48:51], s8 offen offset:2048 sc1
    buffer_load_dwordx4 v[172:175], v8, s[48:51], s8 offen offset:3072 sc1
    s_waitcnt vmcnt(4)
    v_max3_u32 v18, v176, v177, v178
    v_max3_u32 v18, v18, v179, v180
    v_max3_u32 v18, v18, v181, v182
    v_max3_u32 v18, v18, v183, v184
    v_max3_u32 v18, v18, v185, v186
    v_max3_u32 v18, v18, v187, v188
    v_max3_u32 v18, v18, v189, v190
    v_max_u32 v18, v18, v191
    v_cmp_eq_u32 vcc, -1, v18
    s_cbranch_vccz Lp2_37
    s_sub_u32 s74, s74, 1
    s_cbranch_scc1 L_fail
    buffer_load_dwordx4 v[176:179], v8, s[48:51], s8 offen offset:0 sc1
    buffer_load_dwordx4 v[180:183], v8, s[48:51], s8 offen offset:1024 sc1
    buffer_load_dwordx4 v[184:187], v8, s[48:51], s8 offen offset:2048 sc1
    buffer_load_dwordx4 v[188:191], v8, s[48:51], s8 offen offset:3072 sc1
    s_branch Lp2_35
Lp2_37:
    v_mov_b32 v232, v176
    v_mov_b32 v233, v177
    v_mov_b32 v234, v178
    v_mov_b32 v235, v179
    v_mov_b32 v236, v180
    v_mov_b32 v237, v181
    v_mov_b32 v238, v182
    v_mov_b32 v239, v183
    v_mov_b32 v240, v184
    v_mov_b32 v241, v185
    v_mov_b32 v242, v186
    v_mov_b32 v243, v187
    v_mov_b32 v244, v188
    v_mov_b32 v245, v189
    v_mov_b32 v246, v190
    v_mov_b32 v247, v191
    s_branch Lp2_38
Lp2_36:
    v_mov_b32 v232, v160
    v_mov_b32 v233, v161
    v_mov_b32 v234, v162
    v_mov_b32 v235, v163
    v_mov_b32 v236, v164
    v_mov_b32 v237, v165
    v_mov_b32 v238, v166
    v_mov_b32 v239, v167
    v_mov_b32 v240, v168
    v_mov_b32 v241, v169
    v_mov_b32 v242, v170
    v_mov_b32 v243, v171
    v_mov_b32 v244, v172
    v_mov_b32 v245, v173
    v_mov_b32 v246, v174
    v_mov_b32 v247, v175
Lp2_38:
    s_nop 1
    ds_write_b128 v14, v[232:235] offset:0
    ds_write_b128 v15, v[236:239] offset:1024
    ds_write_b128 v16, v[240:243] offset:2048
    ds_write_b128 v17, v[244:247] offset:3072
    s_waitcnt lgkmcnt(0)
    s_barrier
    ds_read_b128 v[200:203], v20 offset:0
    ds_read_b128 v[204:207], v20 offset:16384
    ds_read_b128 v[208:211], v21 offset:0
    ds_read_b128 v[212:215], v21 offset:16384
    ds_read_b128 v[216:219], v22 offset:0
    ds_read_b128 v[220:223], v22 offset:16384
    ds_read_b128 v[224:227], v23 offset:0
    ds_read_b128 v[228:231], v23 offset:16384
    s_waitcnt vmcnt(0)
    ds_read_b128 v[160:163], v20 offset:256
    ds_read_b128 v[164:167], v20 offset:16640
    ds_read_b128 v[168:171], v21 offset:256
    ds_read_b128 v[172:175], v21 offset:16640
    ds_read_b128 v[176:179], v22 offset:256
    ds_read_b128 v[180:183], v22 offset:16640
    ds_read_b128 v[184:187], v23 offset:256
    ds_read_b128 v[188:191], v23 offset:16640
    s_waitcnt lgkmcnt(8)
    v_mfma_f32_16x16x32_bf16 v[192:195], v[32:35], v[200:203], 0
    v_mfma_f32_16x16x32_bf16 v[196:199], v[32:35], v[204:207], 0
    v_mfma_f32_16x16x32_bf16 v[192:195], v[36:39], v[208:211], v[192:195]
    v_mfma_f32_16x16x32_bf16 v[196:199], v[36:39], v[212:215], v[196:199]
    v_mfma_f32_16x16x32_bf16 v[192:195], v[40:43], v[216:219], v[192:195]
    v_mfma_f32_16x16x32_bf16 v[196:199], v[40:43], v[220:223], v[196:199]
    v_mfma_f32_16x16x32_bf16 v[192:195], v[44:47], v[224:227], v[192:195]
    v_mfma_f32_16x16x32_bf16 v[196:199], v[44:47], v[228:231], v[196:199]
    ds_read_b128 v[200:203], v20 offset:512
    ds_read_b128 v[204:207], v20 offset:16896
    ds_read_b128 v[208:211], v21 offset:512
    ds_read_b128 v[212:215], v21 offset:16896
    ds_read_b128 v[216:219], v22 offset:512
    ds_read_b128 v[220:223], v22 offset:16896
    ds_read_b128 v[224:227], v23 offset:512
    ds_read_b128 v[228:231], v23 offset:16896
    s_waitcnt lgkmcnt(8)
    v_mfma_f32_16x16x32_bf16 v[192:195], v[48:51], v[160:163], v[192:195]
    v_mfma_f32_16x16x32_bf16 v[196:199], v[48:51], v[164:167], v[196:199]
    v_mfma_f32_16x16x32_bf16 v[192:195], v[52:55], v[168:171], v[192:195]
    v_mfma_f32_16x16x32_bf16 v[196:199], v[52:55], v[172:175], v[196:199]
    v_mfma_f32_16x16x32_bf16 v[192:195], v[56:59], v[176:179], v[192:195]
    v_mfma_f32_16x16x32_bf16 v[196:199], v[56:59], v[180:183], v[196:199]
    v_mfma_f32_16x16x32_bf16 v[192:195], v[60:63], v[184:187], v[192:195]
    v_mfma_f32_16x16x32_bf16 v[196:199], v[60:63], v[188:191], v[196:199]
    ds_read_b128 v[160:163], v20 offset:768
    ds_read_b128 v[164:167], v20 offset:17152
    ds_read_b128 v[168:171], v21 offset:768
    ds_read_b128 v[172:175], v21 offset:17152
    ds_read_b128 v[176:179], v22 offset:768
    ds_read_b128 v[180:183], v22 offset:17152
    ds_read_b128 v[184:187], v23 offset:768
    ds_read_b128 v[188:191], v23 offset:17152
    s_waitcnt lgkmcnt(8)
    v_mfma_f32_16x16x32_bf16 v[192:195], v[64:67], v[200:203], v[192:195]
    v_mfma_f32_16x16x32_bf16 v[196:199], v[64:67], v[204:207], v[196:199]
    v_mfma_f32_16x16x32_bf16 v[192:195], v[68:71], v[208:211], v[192:195]
    v_mfma_f32_16x16x32_bf16 v[196:199], v[68:71], v[212:215], v[196:199]
    v_mfma_f32_16x16x32_bf16 v[192:195], v[72:75], v[216:219], v[192:195]
    v_mfma_f32_16x16x32_bf16 v[196:199], v[72:75], v[220:223], v[196:199]
    v_mfma_f32_16x16x32_bf16 v[192:195], v[76:79], v[224:227], v[192:195]
    v_mfma_f32_16x16x32_bf16 v[196:199], v[76:79], v[228:231], v[196:199]
    s_waitcnt lgkmcnt(0)
    v_mfma_f32_16x16x32_bf16 v[192:195], v[80:83], v[160:163], v[192:195]
    v_mfma_f32_16x16x32_bf16 v[196:199], v[80:83], v[164:167], v[196:199]
    v_mfma_f32_16x16x32_bf16 v[192:195], v[84:87], v[168:171], v[192:195]
    v_mfma_f32_16x16x32_bf16 v[196:199], v[84:87], v[172:175], v[196:199]
    v_mfma_f32_16x16x32_bf16 v[192:195], v[88:91], v[176:179], v[192:195]
    v_mfma_f32_16x16x32_bf16 v[196:199], v[88:91], v[180:183], v[196:199]
    v_mfma_f32_16x16x32_bf16 v[192:195], v[92:95], v[184:187], v[192:195]
    v_mfma_f32_16x16x32_bf16 v[196:199], v[92:95], v[188:191], v[196:199]
    v_lshlrev_b32 v18, 5, v2
    s_lshl_b32 s9, s3, 2
    v_add_u32 v19, s9, v18
    s_nop 4
    v_max3_f32 v232, v192, v193, v194
    v_max_f32 v232, v232, v195
    v_max3_f32 v233, v196, v197, v198
    v_max_f32 v233, v233, v199
    v_mov_b32 v234, v232
    v_mov_b32 v235, v233
    s_nop 0
    v_permlane16_swap_b32 v232, v234
    v_permlane16_swap_b32 v233, v235
    s_nop 0
    v_max_f32 v232, v232, v234
    v_max_f32 v233, v233, v235
    v_mov_b32 v234, v232
    v_mov_b32 v235, v233
    s_nop 0
    v_permlane32_swap_b32 v232, v234
    v_permlane32_swap_b32 v233, v235
    s_nop 0
    v_max_f32 v232, v232, v234
    v_max_f32 v233, v233, v235
    ds_write_b32 v19, v232 offset:40960
    ds_write_b32 v19, v233 offset:41472
    v_lshrrev_b32 v14, 1, v3
    s_lshl_b32 s9, s3, 1
    v_add_u32 v14, s9, v14
    v_xor_b32 v14, v14, v2
    v_lshlrev_b32 v14, 4, v14
    v_and_b32 v15, 1, v3
    v_lshl_add_u32 v14, v15, 3, v14
    v_lshl_add_u32 v14, v2, 8, v14
    s_waitcnt lgkmcnt(0)
    s_barrier
    ds_read_b128 v[236:239], v18 offset:40960
    ds_read_b128 v[240:243], v18 offset:40976
    ds_read_b128 v[244:247], v18 offset:41472
    ds_read_b128 v[248:251], v18 offset:41488
    s_waitcnt lgkmcnt(0)
    v_max3_f32 v232, v236, v237, v238
    v_max3_f32 v234, v239, v240, v241
    v_max3_f32 v233, v244, v245, v246
    v_max3_f32 v235, v247, v248, v249
    v_max3_f32 v232, v232, v242, v243
    v_max_f32 v232, v232, v234
    v_max3_f32 v233, v233, v250, v251
    v_max_f32 v233, v233, v235
    v_sub_f32 v192, v192, v232
    v_sub_f32 v193, v193, v232
    v_sub_f32 v194, v194, v232
    v_sub_f32 v195, v195, v232
    v_sub_f32 v196, v196, v233
    v_sub_f32 v197, v197, v233
    v_sub_f32 v198, v198, v233
    v_sub_f32 v199, v199, v233
    v_exp_f32 v192, v192
    v_exp_f32 v193, v193
    v_exp_f32 v194, v194
    v_exp_f32 v195, v195
    v_exp_f32 v196, v196
    v_exp_f32 v197, v197
    v_exp_f32 v198, v198
    v_exp_f32 v199, v199
    s_nop 0
    v_cvt_pk_bf16_f32 v236, v192, v193
    v_cvt_pk_bf16_f32 v237, v194, v195
    v_cvt_pk_bf16_f32 v238, v196, v197
    v_cvt_pk_bf16_f32 v239, v198, v199
    ds_write_b64 v14, v[236:237] offset:32768
    ds_write_b64 v14, v[238:239] offset:36864
    v_add_f32 v234, v192, v193
    v_add_f32 v240, v194, v195
    v_add_f32 v234, v234, v240
    v_add_f32 v235, v196, v197
    v_add_f32 v241, v198, v199
    v_add_f32 v235, v235, v241
    v_mov_b32 v240, v234
    v_mov_b32 v241, v235
    s_nop 0
    v_permlane16_swap_b32 v234, v240
    v_permlane16_swap_b32 v235, v241
    s_nop 0
    v_add_f32 v234, v234, v240
    v_add_f32 v235, v235, v241
    v_mov_b32 v240, v234
    v_mov_b32 v241, v235
    s_nop 0
    v_permlane32_swap_b32 v234, v240
    v_permlane32_swap_b32 v235, v241
    s_nop 0
    v_add_f32 v234, v234, v240
    v_add_f32 v235, v235, v241
    ds_write_b32 v19, v234 offset:41984
    ds_write_b32 v19, v235 offset:42496
    v_xor_b32 v19, v3, v2
    v_lshlrev_b32 v19, 4, v19
    v_lshl_add_u32 v19, v2, 8, v19
    v_xor_b32 v24, 0, v19
    v_xor_b32 v25, 64, v19
    v_xor_b32 v26, 128, v19
    v_xor_b32 v27, 192, v19
    s_waitcnt lgkmcnt(0)
    s_barrier
    ds_read_b128 v[160:163], v24 offset:32768
    ds_read_b128 v[164:167], v25 offset:32768
    ds_read_b128 v[168:171], v26 offset:32768
    ds_read_b128 v[172:175], v27 offset:32768
    ds_read_b128 v[176:179], v24 offset:36864
    ds_read_b128 v[180:183], v25 offset:36864
    ds_read_b128 v[184:187], v26 offset:36864
    ds_read_b128 v[188:191], v27 offset:36864
    v_lshlrev_b32 v18, 17, v3
    v_lshl_add_u32 v18, v2, 3, v18
    s_lshl_b32 s9, s3, 7
    s_add_u32 s9, s9, s7
    s_waitcnt lgkmcnt(7)
    v_mfma_f32_16x16x32_bf16 v[200:203], v[160:163], v[96:99], 0
    v_mfma_f32_16x16x32_bf16 v[204:207], v[160:163], v[112:115], 0
    v_mfma_f32_16x16x32_bf16 v[208:211], v[160:163], v[128:131], 0
    v_mfma_f32_16x16x32_bf16 v[212:215], v[160:163], v[144:147], 0
    s_waitcnt lgkmcnt(6)
    v_mfma_f32_16x16x32_bf16 v[200:203], v[164:167], v[100:103], v[200:203]
    v_mfma_f32_16x16x32_bf16 v[204:207], v[164:167], v[116:119], v[204:207]
    v_mfma_f32_16x16x32_bf16 v[208:211], v[164:167], v[132:135], v[208:211]
    v_mfma_f32_16x16x32_bf16 v[212:215], v[164:167], v[148:151], v[212:215]
    s_waitcnt lgkmcnt(5)
    v_mfma_f32_16x16x32_bf16 v[200:203], v[168:171], v[104:107], v[200:203]
    v_mfma_f32_16x16x32_bf16 v[204:207], v[168:171], v[120:123], v[204:207]
    v_mfma_f32_16x16x32_bf16 v[208:211], v[168:171], v[136:139], v[208:211]
    v_mfma_f32_16x16x32_bf16 v[212:215], v[168:171], v[152:155], v[212:215]
    s_waitcnt lgkmcnt(4)
    v_mfma_f32_16x16x32_bf16 v[200:203], v[172:175], v[108:111], v[200:203]
    v_mfma_f32_16x16x32_bf16 v[204:207], v[172:175], v[124:127], v[204:207]
    v_mfma_f32_16x16x32_bf16 v[208:211], v[172:175], v[140:143], v[208:211]
    v_mfma_f32_16x16x32_bf16 v[212:215], v[172:175], v[156:159], v[212:215]
    s_waitcnt lgkmcnt(3)
    v_mfma_f32_16x16x32_bf16 v[216:219], v[176:179], v[96:99], 0
    v_mfma_f32_16x16x32_bf16 v[220:223], v[176:179], v[112:115], 0
    v_mfma_f32_16x16x32_bf16 v[224:227], v[176:179], v[128:131], 0
    v_mfma_f32_16x16x32_bf16 v[228:231], v[176:179], v[144:147], 0
    s_waitcnt lgkmcnt(2)
    v_mfma_f32_16x16x32_bf16 v[216:219], v[180:183], v[100:103], v[216:219]
    v_mfma_f32_16x16x32_bf16 v[220:223], v[180:183], v[116:119], v[220:223]
    v_mfma_f32_16x16x32_bf16 v[224:227], v[180:183], v[132:135], v[224:227]
    v_mfma_f32_16x16x32_bf16 v[228:231], v[180:183], v[148:151], v[228:231]
    s_waitcnt lgkmcnt(1)
    v_mfma_f32_16x16x32_bf16 v[216:219], v[184:187], v[104:107], v[216:219]
    v_mfma_f32_16x16x32_bf16 v[220:223], v[184:187], v[120:123], v[220:223]
    v_mfma_f32_16x16x32_bf16 v[224:227], v[184:187], v[136:139], v[224:227]
    v_mfma_f32_16x16x32_bf16 v[228:231], v[184:187], v[152:155], v[228:231]
    s_waitcnt lgkmcnt(0)
    v_mfma_f32_16x16x32_bf16 v[216:219], v[188:191], v[108:111], v[216:219]
    v_mfma_f32_16x16x32_bf16 v[220:223], v[188:191], v[124:127], v[220:223]
    v_mfma_f32_16x16x32_bf16 v[224:227], v[188:191], v[140:143], v[224:227]
    v_mfma_f32_16x16x32_bf16 v[228:231], v[188:191], v[156:159], v[228:231]
    v_cvt_pk_bf16_f32 v32, v200, v204
    v_cvt_pk_bf16_f32 v33, v208, v212
    s_add_u32 s10, s9, 0
    buffer_store_dwordx2 v[32:33], v18, s[48:51], s10 offen sc1
    v_cvt_pk_bf16_f32 v34, v201, v205
    v_cvt_pk_bf16_f32 v35, v209, v213
    s_add_u32 s10, s9, 32768
    buffer_store_dwordx2 v[34:35], v18, s[48:51], s10 offen sc1
    v_cvt_pk_bf16_f32 v36, v202, v206
    v_cvt_pk_bf16_f32 v37, v210, v214
    s_add_u32 s10, s9, 65536
    buffer_store_dwordx2 v[36:37], v18, s[48:51], s10 offen sc1
    v_cvt_pk_bf16_f32 v38, v203, v207
    v_cvt_pk_bf16_f32 v39, v211, v215
    s_add_u32 s10, s9, 98304
    buffer_store_dwordx2 v[38:39], v18, s[48:51], s10 offen sc1
    s_cmp_lg_u32 s3, 6
    s_cbranch_scc1 L_39
    v_and_b32 v14, 31, v1
    v_lshlrev_b32 v19, 5, v14
    ds_read_b128 v[236:239], v19 offset:41984
    ds_read_b128 v[240:243], v19 offset:42000
    ds_read_b128 v[244:247], v19 offset:40960
    ds_read_b128 v[248:251], v19 offset:40976
L_39:
    s_nop 4
    v_cvt_pk_bf16_f32 v40, v216, v220
    v_cvt_pk_bf16_f32 v41, v224, v228
    s_add_u32 s10, s9, 524288
    buffer_store_dwordx2 v[40:41], v18, s[48:51], s10 offen sc1
    v_cvt_pk_bf16_f32 v42, v217, v221
    v_cvt_pk_bf16_f32 v43, v225, v229
    s_add_u32 s10, s9, 557056
    buffer_store_dwordx2 v[42:43], v18, s[48:51], s10 offen sc1
    v_cvt_pk_bf16_f32 v44, v218, v222
    v_cvt_pk_bf16_f32 v45, v226, v230
    s_add_u32 s10, s9, 589824
    buffer_store_dwordx2 v[44:45], v18, s[48:51], s10 offen sc1
    v_cvt_pk_bf16_f32 v46, v219, v223
    v_cvt_pk_bf16_f32 v47, v227, v231
    s_add_u32 s10, s9, 622592
    buffer_store_dwordx2 v[46:47], v18, s[48:51], s10 offen sc1
    s_cmp_lg_u32 s3, 6
    s_cbranch_scc1 L_40
    s_waitcnt lgkmcnt(0)
    v_add_f32 v236, v236, v237
    v_add_f32 v238, v238, v239
    v_add_f32 v240, v240, v241
    v_add_f32 v242, v242, v243
    v_add_f32 v236, v236, v238
    v_add_f32 v240, v240, v242
    v_add_f32 v237, v236, v240
    v_max3_f32 v236, v244, v245, v246
    v_max3_f32 v236, v236, v247, v248
    v_max3_f32 v236, v236, v249, v250
    v_max_f32 v236, v236, v251
    v_xor_b32 v238, s78, v236
    v_xor_b32 v239, s78, v237
    v_lshlrev_b32 v14, 12, v14
L_40:
    s_waitcnt vmcnt(0)
    s_barrier
    s_cmp_lg_u32 s3, 6
    s_cbranch_scc1 L_41
    buffer_store_dwordx4 v[236:239], v14, s[48:51], s12 offen sc1
L_41:
    s_cmp_lg_u32 s76, 0
    s_cbranch_scc1 L_42
    s_cmp_lt_u32 s4, 20
    s_cbranch_scc1 L_42
    v_bfe_u32 v16, v1, 3, 1
    v_lshlrev_b32 v16, 2, v16
    v_add_u32 v16, v16, v3
    s_mov_b32 s10, 1024
    v_mul_lo_u32 v15, s10, v16
    v_and_b32 v16, 7, v1
    v_lshl_add_u32 v15, v16, 4, v15
    s_lshl_b32 s9, s3, 13
    s_add_u32 s9, s9, 45056
    v_add_u32 v15, s9, v15
    ds_read_b128 v[32:35], v15 offset:0
    ds_read_b128 v[36:39], v15 offset:128
    ds_read_b128 v[40:43], v15 offset:256
    ds_read_b128 v[44:47], v15 offset:384
    ds_read_b128 v[48:51], v15 offset:512
    ds_read_b128 v[52:55], v15 offset:640
    ds_read_b128 v[56:59], v15 offset:768
    ds_read_b128 v[60:63], v15 offset:896
    s_cmp_ge_u32 s3, 2
    s_cbranch_scc1 L_43
    v_add_u32 v15, 0x10000, v15
    ds_read_b128 v[64:67], v15 offset:0
    ds_read_b128 v[68:71], v15 offset:128
    ds_read_b128 v[72:75], v15 offset:256
    ds_read_b128 v[76:79], v15 offset:384
    ds_read_b128 v[80:83], v15 offset:512
    ds_read_b128 v[84:87], v15 offset:640
    ds_read_b128 v[88:91], v15 offset:768
    ds_read_b128 v[92:95], v15 offset:896
L_43:
    v_mov_b32 v128, v4
    v_mov_b32 v132, v252
    v_mov_b32 v129, v5
    v_mov_b32 v133, v253
    v_mov_b32 v130, v6
    v_mov_b32 v134, v254
    v_mov_b32 v131, v7
    v_mov_b32 v135, v255
    s_mov_b32 s10, 0xbfb8aa3b
    v_lshlrev_b32 v192, 16, v128
    v_and_b32 v193, 0xffff0000, v128
    v_lshlrev_b32 v194, 16, v129
    v_and_b32 v195, 0xffff0000, v129
    v_lshlrev_b32 v196, 16, v130
    v_and_b32 v197, 0xffff0000, v130
    v_lshlrev_b32 v198, 16, v131
    v_and_b32 v199, 0xffff0000, v131
    v_lshlrev_b32 v200, 16, v132
    v_and_b32 v201, 0xffff0000, v132
    v_lshlrev_b32 v202, 16, v133
    v_and_b32 v203, 0xffff0000, v133
    v_lshlrev_b32 v204, 16, v134
    v_and_b32 v205, 0xffff0000, v134
    v_lshlrev_b32 v206, 16, v135
    v_and_b32 v207, 0xffff0000, v135
    v_mul_f32 v208, s10, v192
    v_mul_f32 v209, s10, v193
    v_mul_f32 v210, s10, v194
    v_mul_f32 v211, s10, v195
    v_mul_f32 v212, s10, v196
    v_mul_f32 v213, s10, v197
    v_mul_f32 v214, s10, v198
    v_mul_f32 v215, s10, v199
    v_mul_f32 v216, s10, v200
    v_mul_f32 v217, s10, v201
    v_mul_f32 v218, s10, v202
    v_mul_f32 v219, s10, v203
    v_mul_f32 v220, s10, v204
    v_mul_f32 v221, s10, v205
    v_mul_f32 v222, s10, v206
    v_mul_f32 v223, s10, v207
    v_exp_f32 v208, v208
    v_exp_f32 v209, v209
    v_exp_f32 v210, v210
    v_exp_f32 v211, v211
    v_exp_f32 v212, v212
    v_exp_f32 v213, v213
    v_exp_f32 v214, v214
    v_exp_f32 v215, v215
    v_exp_f32 v216, v216
    v_exp_f32 v217, v217
    v_exp_f32 v218, v218
    v_exp_f32 v219, v219
    v_exp_f32 v220, v220
    v_exp_f32 v221, v221
    v_exp_f32 v222, v222
    v_exp_f32 v223, v223
    v_add_f32 v208, 1.0, v208
    v_add_f32 v209, 1.0, v209
    v_add_f32 v210, 1.0, v210
    v_add_f32 v211, 1.0, v211
    v_add_f32 v212, 1.0, v212
    v_add_f32 v213, 1.0, v213
    v_add_f32 v214, 1.0, v214
    v_add_f32 v215, 1.0, v215
    v_add_f32 v216, 1.0, v216
    v_add_f32 v217, 1.0, v217
    v_add_f32 v218, 1.0, v218
    v_add_f32 v219, 1.0, v219
    v_add_f32 v220, 1.0, v220
    v_add_f32 v221, 1.0, v221
    v_add_f32 v222, 1.0, v222
    v_add_f32 v223, 1.0, v223
    v_rcp_f32 v208, v208
    v_rcp_f32 v209, v209
    v_rcp_f32 v210, v210
    v_rcp_f32 v211, v211
    v_rcp_f32 v212, v212
    v_rcp_f32 v213, v213
    v_rcp_f32 v214, v214
    v_rcp_f32 v215, v215
    v_rcp_f32 v216, v216
    v_rcp_f32 v217, v217
    v_rcp_f32 v218, v218
    v_rcp_f32 v219, v219
    v_rcp_f32 v220, v220
    v_rcp_f32 v221, v221
    v_rcp_f32 v222, v222
    v_rcp_f32 v223, v223
    v_mul_f32 v192, v192, v208
    v_mul_f32 v193, v193, v209
    v_mul_f32 v194, v194, v210
    v_mul_f32 v195, v195, v211
    v_mul_f32 v196, v196, v212
    v_mul_f32 v197, v197, v213
    v_mul_f32 v198, v198, v214
    v_mul_f32 v199, v199, v215
    v_mul_f32 v200, v200, v216
    v_mul_f32 v201, v201, v217
    v_mul_f32 v202, v202, v218
    v_mul_f32 v203, v203, v219
    v_mul_f32 v204, v204, v220
    v_mul_f32 v205, v205, v221
    v_mul_f32 v206, v206, v222
    v_mul_f32 v207, v207, v223
    v_cvt_pk_bf16_f32 v128, v192, v193
    v_cvt_pk_bf16_f32 v129, v194, v195
    v_cvt_pk_bf16_f32 v130, v196, v197
    v_cvt_pk_bf16_f32 v131, v198, v199
    v_cvt_pk_bf16_f32 v132, v200, v201
    v_cvt_pk_bf16_f32 v133, v202, v203
    v_cvt_pk_bf16_f32 v134, v204, v205
    v_cvt_pk_bf16_f32 v135, v206, v207
    s_waitcnt lgkmcnt(0)
    v_perm_b32 v96, v36, v32, s72
    v_perm_b32 v97, v44, v40, s72
    v_perm_b32 v98, v52, v48, s72
    v_perm_b32 v99, v60, v56, s72
    v_perm_b32 v100, v36, v32, s73
    v_perm_b32 v101, v44, v40, s73
    v_perm_b32 v102, v52, v48, s73
    v_perm_b32 v103, v60, v56, s73
    v_perm_b32 v104, v37, v33, s72
    v_perm_b32 v105, v45, v41, s72
    v_perm_b32 v106, v53, v49, s72
    v_perm_b32 v107, v61, v57, s72
    v_perm_b32 v108, v37, v33, s73
    v_perm_b32 v109, v45, v41, s73
    v_perm_b32 v110, v53, v49, s73
    v_perm_b32 v111, v61, v57, s73
    v_perm_b32 v112, v38, v34, s72
    v_perm_b32 v113, v46, v42, s72
    v_perm_b32 v114, v54, v50, s72
    v_perm_b32 v115, v62, v58, s72
    v_perm_b32 v116, v38, v34, s73
    v_perm_b32 v117, v46, v42, s73
    v_perm_b32 v118, v54, v50, s73
    v_perm_b32 v119, v62, v58, s73
    v_perm_b32 v120, v39, v35, s72
    v_perm_b32 v121, v47, v43, s72
    v_perm_b32 v122, v55, v51, s72
    v_perm_b32 v123, v63, v59, s72
    v_perm_b32 v124, v39, v35, s73
    v_perm_b32 v125, v47, v43, s73
    v_perm_b32 v126, v55, v51, s73
    v_perm_b32 v127, v63, v59, s73
    v_mfma_f32_16x16x32_bf16 v[160:163], v[128:131], v[96:99], 0
    v_mfma_f32_16x16x32_bf16 v[164:167], v[128:131], v[100:103], 0
    v_mfma_f32_16x16x32_bf16 v[168:171], v[128:131], v[104:107], 0
    v_mfma_f32_16x16x32_bf16 v[172:175], v[128:131], v[108:111], 0
    v_mfma_f32_16x16x32_bf16 v[176:179], v[128:131], v[112:115], 0
    v_mfma_f32_16x16x32_bf16 v[180:183], v[128:131], v[116:119], 0
    v_mfma_f32_16x16x32_bf16 v[184:187], v[128:131], v[120:123], 0
    v_mfma_f32_16x16x32_bf16 v[188:191], v[128:131], v[124:127], 0
    s_cmp_ge_u32 s3, 2
    s_cbranch_scc1 L_44
    v_perm_b32 v32, v68, v64, s72
    v_perm_b32 v33, v76, v72, s72
    v_perm_b32 v34, v84, v80, s72
    v_perm_b32 v35, v92, v88, s72
    v_perm_b32 v36, v68, v64, s73
    v_perm_b32 v37, v76, v72, s73
    v_perm_b32 v38, v84, v80, s73
    v_perm_b32 v39, v92, v88, s73
    v_perm_b32 v40, v69, v65, s72
    v_perm_b32 v41, v77, v73, s72
    v_perm_b32 v42, v85, v81, s72
    v_perm_b32 v43, v93, v89, s72
    v_perm_b32 v44, v69, v65, s73
    v_perm_b32 v45, v77, v73, s73
    v_perm_b32 v46, v85, v81, s73
    v_perm_b32 v47, v93, v89, s73
    v_perm_b32 v48, v70, v66, s72
    v_perm_b32 v49, v78, v74, s72
    v_perm_b32 v50, v86, v82, s72
    v_perm_b32 v51, v94, v90, s72
    v_perm_b32 v52, v70, v66, s73
    v_perm_b32 v53, v78, v74, s73
    v_perm_b32 v54, v86, v82, s73
    v_perm_b32 v55, v94, v90, s73
    v_perm_b32 v56, v71, v67, s72
    v_perm_b32 v57, v79, v75, s72
    v_perm_b32 v58, v87, v83, s72
    v_perm_b32 v59, v95, v91, s72
    v_perm_b32 v60, v71, v67, s73
    v_perm_b32 v61, v79, v75, s73
    v_perm_b32 v62, v87, v83, s73
    v_perm_b32 v63, v95, v91, s73
    s_nop 1
    v_mfma_f32_16x16x32_bf16 v[160:163], v[132:135], v[32:35], v[160:163]
    v_mfma_f32_16x16x32_bf16 v[164:167], v[132:135], v[36:39], v[164:167]
    v_mfma_f32_16x16x32_bf16 v[168:171], v[132:135], v[40:43], v[168:171]
    v_mfma_f32_16x16x32_bf16 v[172:175], v[132:135], v[44:47], v[172:175]
    v_mfma_f32_16x16x32_bf16 v[176:179], v[132:135], v[48:51], v[176:179]
    v_mfma_f32_16x16x32_bf16 v[180:183], v[132:135], v[52:55], v[180:183]
    v_mfma_f32_16x16x32_bf16 v[184:187], v[132:135], v[56:59], v[184:187]
    v_mfma_f32_16x16x32_bf16 v[188:191], v[132:135], v[60:63], v[188:191]
L_44:
    s_lshl_b32 s11, s3, 10
    s_add_u32 s11, s11, 131072
    v_add_u32 v18, s11, v8
    s_nop 6
    v_cndmask_b32 v192, v160, v177, s[46:47]
    v_cndmask_b32 v196, v176, v161, s[46:47]
    v_cndmask_b32 v193, v164, v181, s[46:47]
    v_cndmask_b32 v197, v180, v165, s[46:47]
    v_cndmask_b32 v194, v168, v185, s[46:47]
    v_cndmask_b32 v198, v184, v169, s[46:47]
    v_cndmask_b32 v195, v172, v189, s[46:47]
    v_cndmask_b32 v199, v188, v173, s[46:47]
    s_nop 0
    v_add_f32_dpp v192, v196, v192 row_ror:8 row_mask:0xf bank_mask:0xf
    v_add_f32_dpp v193, v197, v193 row_ror:8 row_mask:0xf bank_mask:0xf
    v_add_f32_dpp v194, v198, v194 row_ror:8 row_mask:0xf bank_mask:0xf
    v_add_f32_dpp v195, v199, v195 row_ror:8 row_mask:0xf bank_mask:0xf
    ds_write_b128 v18, v[192:195]
    s_mov_b32 s11, 131072
    v_add_u32 v18, s11, v8
    s_movk_i32 s10, 7680
    v_mul_lo_u32 v19, s10, v3
    v_and_b32 v14, 7, v2
    v_lshl_add_u32 v19, v14, 4, v19
    v_lshrrev_b32 v14, 3, v2
    v_lshl_add_u32 v19, v14, 3, v19
    s_waitcnt lgkmcnt(0)
    s_barrier
    s_cmp_lg_u32 s3, 0
    s_cbranch_scc1 L_45
    ds_read_b128 v[200:203], v18 offset:0
    ds_read_b128 v[204:207], v18 offset:1024
    ds_read_b128 v[208:211], v18 offset:2048
    ds_read_b128 v[212:215], v18 offset:3072
    ds_read_b128 v[216:219], v18 offset:4096
    ds_read_b128 v[220:223], v18 offset:5120
    ds_read_b128 v[224:227], v18 offset:6144
    ds_read_b128 v[228:231], v18 offset:7168
    s_cmp_eq_u32 s14, 4
    s_cselect_b32 s10, 1.0, 0
    s_waitcnt lgkmcnt(0)
    v_pk_add_f32 v[200:201], v[200:201], v[216:217]
    v_pk_add_f32 v[202:203], v[202:203], v[218:219]
    v_pk_add_f32 v[204:205], v[204:205], v[220:221]
    v_pk_add_f32 v[206:207], v[206:207], v[222:223]
    v_pk_add_f32 v[208:209], v[208:209], v[224:225]
    v_pk_add_f32 v[210:211], v[210:211], v[226:227]
    v_pk_add_f32 v[212:213], v[212:213], v[228:229]
    v_pk_add_f32 v[214:215], v[214:215], v[230:231]
    v_pk_add_f32 v[200:201], v[200:201], v[208:209]
    v_pk_add_f32 v[202:203], v[202:203], v[210:211]
    v_pk_add_f32 v[204:205], v[204:205], v[212:213]
    v_pk_add_f32 v[206:207], v[206:207], v[214:215]
    v_pk_add_f32 v[200:201], v[200:201], v[204:205]
    v_pk_add_f32 v[202:203], v[202:203], v[206:207]
    v_add_f32 v200, s10, v200
    v_add_f32 v201, s10, v201
    v_add_f32 v202, s10, v202
    v_add_f32 v203, s10, v203
    v_cvt_pk_bf16_f32 v200, v200, v201
    v_cvt_pk_bf16_f32 v201, v202, v203
    v_min_u32 v200, -2, v200
    v_min_u32 v201, -2, v201
    buffer_store_dwordx2 v[200:201], v19, s[48:51], s13 offen sc1
L_45:
    s_barrier
L_42:
    s_cmp_eq_u32 s76, 1
    s_cbranch_scc1 LT5_46
    s_cmp_eq_u32 s76, 2
    s_cbranch_scc1 LT6_47
    s_cmp_eq_u32 s76, 3
    s_cbranch_scc1 L_done
    s_cmp_ge_u32 s4, 40
    s_cbranch_scc1 L_done
    s_mov_b32 s60, s40
    s_and_b32 s61, s41, 0xffff
    s_mov_b32 s62, 5120
    s_mov_b32 s63, 0x20000
    s_mov_b32 s68, s16
    s_and_b32 s69, s17, 0xffff
    s_mov_b32 s70, 5120
    s_mov_b32 s71, 0x20000
    s_mul_i32 s8, s14, 1280
    s_add_u32 s8, s8, s15
    v_and_b32 v17, 31, v1
    v_lshlrev_b32 v17, 2, v17
    s_cmp_lg_u32 s3, 0
    s_cbranch_scc1 L_48
    buffer_load_dword v32, v17, s[68:71], s8 offen
    s_mul_i32 s9, s14, 7680
    s_add_u32 s9, s9, s15
    s_add_u32 s9, s9, 6400
    s_add_u32 s64, s8, 229376
    s_add_u32 s65, s8, 234496
    s_add_u32 s66, s8, 239616
    s_add_u32 s67, s8, 244736
Lpoll_49:
    s_sub_u32 s74, s74, 1
    s_cbranch_scc1 L_fail
    buffer_load_dword v33, v17, s[48:51], s9 offen sc1
    buffer_load_dword v34, v17, s[48:51], s64 offen sc1
    buffer_load_dword v35, v17, s[48:51], s65 offen sc1
    buffer_load_dword v36, v17, s[48:51], s66 offen sc1
    buffer_load_dword v37, v17, s[48:51], s67 offen sc1
    s_waitcnt vmcnt(0)
    v_max3_u32 v18, v33, v34, v35
    v_max3_u32 v18, v18, v36, v37
    v_cmp_eq_u32 vcc, -1, v18
    s_cbranch_vccz Lok_50
    s_sleep 8
    s_branch Lpoll_49
Lok_50:
    v_lshlrev_b32 v40, 16, v32
    v_and_b32 v41, 0xffff0000, v32
    v_lshlrev_b32 v42, 16, v34
    v_and_b32 v43, 0xffff0000, v34
    v_add_f32 v40, v40, v42
    v_add_f32 v41, v41, v43
    v_lshlrev_b32 v42, 16, v35
    v_and_b32 v43, 0xffff0000, v35
    v_add_f32 v40, v40, v42
    v_add_f32 v41, v41, v43
    v_lshlrev_b32 v42, 16, v36
    v_and_b32 v43, 0xffff0000, v36
    v_add_f32 v40, v40, v42
    v_add_f32 v41, v41, v43
    v_lshlrev_b32 v42, 16, v37
    v_and_b32 v43, 0xffff0000, v37
    v_add_f32 v40, v40, v42
    v_add_f32 v41, v41, v43
    v_lshlrev_b32 v42, 16, v33
    v_and_b32 v43, 0xffff0000, v33
L_48:
    s_barrier
    s_cmp_ge_u32 s3, 4
    s_cbranch_scc1 L_51
    v_lshrrev_b32 v18, 3, v1
    s_lshl_b32 s9, s3, 3
    v_add_u32 v18, s9, v18
    v_cmp_gt_u32 s[10:11], 27, v18
    v_min_u32 v18, 26, v18
    s_movk_i32 s9, 5120
    v_mul_lo_u32 v18, v18, s9
    v_and_b32 v19, 7, v1
    v_lshl_add_u32 v18, v19, 4, v18
    s_add_u32 s9, s8, 262144
    v_lshlrev_b32 v20, 5, v19
    v_lshl_add_u32 v20, v3, 3, v20
    s_lshl_b32 s64, s3, 8
    v_add_u32 v20, s64, v20
    buffer_load_dwordx4 v[64:67], v18, s[48:51], s9 offen sc1
    s_sleep 3
    buffer_load_dwordx4 v[60:63], v18, s[48:51], s9 offen sc1
Lp2_52:
    s_waitcnt vmcnt(1)
    v_max3_u32 v21, v64, v65, v66
    v_max_u32 v21, v21, v67
    v_cmp_eq_u32 vcc, -1, v21
    s_cbranch_vccz Lp2_53
    buffer_load_dwordx4 v[64:67], v18, s[48:51], s9 offen sc1
    s_waitcnt vmcnt(1)
    v_max3_u32 v21, v60, v61, v62
    v_max_u32 v21, v21, v63
    v_cmp_eq_u32 vcc, -1, v21
    s_cbranch_vccz Lp2_54
    s_sub_u32 s74, s74, 1
    s_cbranch_scc1 L_fail
    buffer_load_dwordx4 v[60:63], v18, s[48:51], s9 offen sc1
    s_branch Lp2_52
Lp2_54:
    v_mov_b32 v48, v60
    v_mov_b32 v49, v61
    v_mov_b32 v50, v62
    v_mov_b32 v51, v63
    s_branch Lp2_55
Lp2_53:
    v_mov_b32 v48, v64
    v_mov_b32 v49, v65
    v_mov_b32 v50, v66
    v_mov_b32 v51, v67
Lp2_55:
    s_nop 1
    v_cndmask_b32 v48, 0, v48, s[10:11]
    v_cndmask_b32 v49, 0, v49, s[10:11]
    v_cndmask_b32 v50, 0, v50, s[10:11]
    v_cndmask_b32 v51, 0, v51, s[10:11]
    v_lshlrev_b32 v52, 16, v48
    v_and_b32 v53, 0xffff0000, v48
    v_lshlrev_b32 v54, 16, v49
    v_and_b32 v55, 0xffff0000, v49
    v_lshlrev_b32 v56, 16, v50
    v_and_b32 v57, 0xffff0000, v50
    v_lshlrev_b32 v58, 16, v51
    v_and_b32 v59, 0xffff0000, v51
    s_nop 1
    v_permlane32_swap_b32 v52, v56
    v_permlane32_swap_b32 v53, v57
    v_permlane32_swap_b32 v54, v58
    v_permlane32_swap_b32 v55, v59
    s_nop 1
    v_add_f32 v52, v52, v56
    v_add_f32 v53, v53, v57
    v_add_f32 v54, v54, v58
    v_add_f32 v55, v55, v59
    s_nop 1
    v_permlane16_swap_b32 v52, v54
    v_permlane16_swap_b32 v53, v55
    s_nop 1
    v_add_f32 v52, v52, v54
    v_add_f32 v53, v53, v55
    s_nop 1
    v_add_f32_dpp v52, v52, v52 row_ror:8 row_mask:0xf bank_mask:0xf
    v_add_f32_dpp v53, v53, v53 row_ror:8 row_mask:0xf bank_mask:0xf
    ds_write_b64 v20, v[52:53]
L_51:
    v_lshlrev_b32 v20, 1, v17
    s_waitcnt lgkmcnt(0)
    s_barrier
    s_cmp_lg_u32 s3, 0
    s_cbranch_scc1 L_done
    ds_read_b64 v[52:53], v20 offset:0
    ds_read_b64 v[54:55], v20 offset:256
    ds_read_b64 v[56:57], v20 offset:512
    ds_read_b64 v[58:59], v20 offset:768
    s_waitcnt lgkmcnt(0)
    v_pk_add_f32 v[52:53], v[52:53], v[56:57]
    v_pk_add_f32 v[54:55], v[54:55], v[58:59]
    v_pk_add_f32 v[52:53], v[52:53], v[54:55]
    v_fma_f32 v40, v52, v42, v40
    v_fma_f32 v41, v53, v43, v41
    v_cvt_pk_bf16_f32 v40, v40, v41
    buffer_store_dword v40, v17, s[60:63], s8 offen
    s_cmp_lg_u32 s4, 0
    s_cbranch_scc1 L_56
    v_mov_b32 v44, 0
    v_mov_b32 v45, 0
    s_mov_b64 exec, 1
    buffer_store_dwordx2 v[44:45], off, s[52:55], 0 sc1
    buffer_store_dwordx2 v[44:45], off, s[52:55], 0 offset:128 sc1
    s_mov_b64 exec, -1
L_56:
    s_branch L_done
LT5_46:
    s_mov_b32 s60, s26
    s_and_b32 s61, s27, 0xffff
    s_mov_b32 s62, 5242880
    s_mov_b32 s63, 0x20000
    v_bfe_u32 v11, v1, 3, 1
    v_lshlrev_b32 v11, 2, v11
    v_add_u32 v11, v11, v3
    s_mov_b32 s10, 10240
    v_mul_lo_u32 v10, s10, v11
    v_and_b32 v11, 7, v1
    v_lshl_add_u32 v10, v11, 4, v10
    s_lshl_b32 s8, s15, 10
    s_lshl_b32 s9, s3, 7
    s_add_u32 s8, s8, s9
    s_mul_i32 s8, s8, 1280
    s_lshl_b32 s9, s14, 7
    s_add_u32 s8, s8, s9
    s_add_u32 s9, s8, 0
    buffer_load_dwordx4 v[32:35], v10, s[60:63], s9 offen nt
    s_add_u32 s9, s8, 1280
    buffer_load_dwordx4 v[36:39], v10, s[60:63], s9 offen nt
    s_add_u32 s9, s8, 2560
    buffer_load_dwordx4 v[40:43], v10, s[60:63], s9 offen nt
    s_add_u32 s9, s8, 3840
    buffer_load_dwordx4 v[44:47], v10, s[60:63], s9 offen nt
    s_add_u32 s9, s8, 5120
    buffer_load_dwordx4 v[48:51], v10, s[60:63], s9 offen nt
    s_add_u32 s9, s8, 6400
    buffer_load_dwordx4 v[52:55], v10, s[60:63], s9 offen nt
    s_add_u32 s9, s8, 7680
    buffer_load_dwordx4 v[56:59], v10, s[60:63], s9 offen nt
    s_add_u32 s9, s8, 8960
    buffer_load_dwordx4 v[60:63], v10, s[60:63], s9 offen nt
    s_add_u32 s9, s8, 81920
    buffer_load_dwordx4 v[64:67], v10, s[60:63], s9 offen nt
    s_add_u32 s9, s8, 83200
    buffer_load_dwordx4 v[68:71], v10, s[60:63], s9 offen nt
    s_add_u32 s9, s8, 84480
    buffer_load_dwordx4 v[72:75], v10, s[60:63], s9 offen nt
    s_add_u32 s9, s8, 85760
    buffer_load_dwordx4 v[76:79], v10, s[60:63], s9 offen nt
    s_add_u32 s9, s8, 87040
    buffer_load_dwordx4 v[80:83], v10, s[60:63], s9 offen nt
    s_add_u32 s9, s8, 88320
    buffer_load_dwordx4 v[84:87], v10, s[60:63], s9 offen nt
    s_add_u32 s9, s8, 89600
    buffer_load_dwordx4 v[88:91], v10, s[60:63], s9 offen nt
    s_add_u32 s9, s8, 90880
    buffer_load_dwordx4 v[92:95], v10, s[60:63], s9 offen nt
    s_movk_i32 s10, 7680
    v_mul_lo_u32 v11, s10, v3
    v_and_b32 v12, 7, v2
    v_lshl_add_u32 v11, v12, 4, v11
    v_lshrrev_b32 v12, 3, v2
    v_lshl_add_u32 v11, v12, 3, v11
    s_lshl_b32 s9, s14, 7
    s_add_u32 s9, s9, 2560
    s_cmp_lg_u32 s3, 0
    s_cbranch_scc1 L_57
Lpoll_58:
    s_sub_u32 s74, s74, 1
    s_cbranch_scc1 L_fail
    buffer_load_dwordx2 v[128:129], v11, s[48:51], s9 offen sc1
    s_waitcnt vmcnt(0)
    v_max_u32 v15, v128, v129
    v_cmp_eq_u32 vcc, -1, v15
    s_cbranch_vccz Lok_59
    s_sleep 8
    s_branch Lpoll_58
Lok_59:
    v_lshlrev_b32 v132, 16, v128
    v_and_b32 v133, 0xffff0000, v128
    v_lshlrev_b32 v134, 16, v129
    v_and_b32 v135, 0xffff0000, v129
L_57:
    v_bfe_u32 v12, v1, 2, 2
    s_movk_i32 s10, 8192
    v_mul_lo_u32 v12, v12, s10
    v_and_b32 v14, 1, v1
    v_lshl_add_u32 v12, v14, 6, v12
    v_lshl_add_u32 v12, v3, 4, v12
    s_lshl_b32 s8, s15, 11
    s_lshl_b32 s9, s3, 8
    s_add_u32 s8, s8, s9
    s_add_u32 s8, s8, 163840
    s_lshl_b32 s11, s3, 10
    v_add_u32 v18, s11, v8
    s_movk_i32 s10, 1280
    v_mul_lo_u32 v19, s10, v3
    v_and_b32 v14, 7, v2
    v_lshl_add_u32 v19, v14, 4, v19
    v_lshrrev_b32 v14, 3, v2
    v_lshl_add_u32 v19, v14, 3, v19
    s_waitcnt vmcnt(0)
    v_perm_b32 v96, v36, v32, s72
    v_perm_b32 v97, v44, v40, s72
    v_perm_b32 v98, v52, v48, s72
    v_perm_b32 v99, v60, v56, s72
    v_perm_b32 v100, v36, v32, s73
    v_perm_b32 v101, v44, v40, s73
    v_perm_b32 v102, v52, v48, s73
    v_perm_b32 v103, v60, v56, s73
    v_perm_b32 v104, v37, v33, s72
    v_perm_b32 v105, v45, v41, s72
    v_perm_b32 v106, v53, v49, s72
    v_perm_b32 v107, v61, v57, s72
    v_perm_b32 v108, v37, v33, s73
    v_perm_b32 v109, v45, v41, s73
    v_perm_b32 v110, v53, v49, s73
    v_perm_b32 v111, v61, v57, s73
    v_perm_b32 v112, v38, v34, s72
    v_perm_b32 v113, v46, v42, s72
    v_perm_b32 v114, v54, v50, s72
    v_perm_b32 v115, v62, v58, s72
    v_perm_b32 v116, v38, v34, s73
    v_perm_b32 v117, v46, v42, s73
    v_perm_b32 v118, v54, v50, s73
    v_perm_b32 v119, v62, v58, s73
    v_perm_b32 v120, v39, v35, s72
    v_perm_b32 v121, v47, v43, s72
    v_perm_b32 v122, v55, v51, s72
    v_perm_b32 v123, v63, v59, s72
    v_perm_b32 v124, v39, v35, s73
    v_perm_b32 v125, v47, v43, s73
    v_perm_b32 v126, v55, v51, s73
    v_perm_b32 v127, v63, v59, s73
    v_perm_b32 v32, v68, v64, s72
    v_perm_b32 v33, v76, v72, s72
    v_perm_b32 v34, v84, v80, s72
    v_perm_b32 v35, v92, v88, s72
    v_perm_b32 v36, v68, v64, s73
    v_perm_b32 v37, v76, v72, s73
    v_perm_b32 v38, v84, v80, s73
    v_perm_b32 v39, v92, v88, s73
    v_perm_b32 v40, v69, v65, s72
    v_perm_b32 v41, v77, v73, s72
    v_perm_b32 v42, v85, v81, s72
    v_perm_b32 v43, v93, v89, s72
    v_perm_b32 v44, v69, v65, s73
    v_perm_b32 v45, v77, v73, s73
    v_perm_b32 v46, v85, v81, s73
    v_perm_b32 v47, v93, v89, s73
    v_perm_b32 v48, v70, v66, s72
    v_perm_b32 v49, v78, v74, s72
    v_perm_b32 v50, v86, v82, s72
    v_perm_b32 v51, v94, v90, s72
    v_perm_b32 v52, v70, v66, s73
    v_perm_b32 v53, v78, v74, s73
    v_perm_b32 v54, v86, v82, s73
    v_perm_b32 v55, v94, v90, s73
    v_perm_b32 v56, v71, v67, s72
    v_perm_b32 v57, v79, v75, s72
    v_perm_b32 v58, v87, v83, s72
    v_perm_b32 v59, v95, v91, s72
    v_perm_b32 v60, v71, v67, s73
    v_perm_b32 v61, v79, v75, s73
    v_perm_b32 v62, v87, v83, s73
    v_perm_b32 v63, v95, v91, s73
    buffer_load_dwordx4 v[232:235], v12, s[48:51], s8 offen offset:0 sc1
    buffer_load_dwordx4 v[236:239], v12, s[48:51], s8 offen offset:128 sc1
    s_sleep 3
    buffer_load_dwordx4 v[224:227], v12, s[48:51], s8 offen offset:0 sc1
    buffer_load_dwordx4 v[228:231], v12, s[48:51], s8 offen offset:128 sc1
Lp2_60:
    s_waitcnt vmcnt(2)
    v_max3_u32 v15, v232, v233, v234
    v_max3_u32 v15, v15, v235, v236
    v_max3_u32 v15, v15, v237, v238
    v_max_u32 v15, v15, v239
    v_cmp_eq_u32 vcc, -1, v15
    s_cbranch_vccz Lp2_61
    buffer_load_dwordx4 v[232:235], v12, s[48:51], s8 offen offset:0 sc1
    buffer_load_dwordx4 v[236:239], v12, s[48:51], s8 offen offset:128 sc1
    s_waitcnt vmcnt(2)
    v_max3_u32 v15, v224, v225, v226
    v_max3_u32 v15, v15, v227, v228
    v_max3_u32 v15, v15, v229, v230
    v_max_u32 v15, v15, v231
    v_cmp_eq_u32 vcc, -1, v15
    s_cbranch_vccz Lp2_62
    s_sub_u32 s74, s74, 1
    s_cbranch_scc1 L_fail
    buffer_load_dwordx4 v[224:227], v12, s[48:51], s8 offen offset:0 sc1
    buffer_load_dwordx4 v[228:231], v12, s[48:51], s8 offen offset:128 sc1
    s_branch Lp2_60
Lp2_62:
    v_mov_b32 v136, v224
    v_mov_b32 v137, v225
    v_mov_b32 v138, v226
    v_mov_b32 v139, v227
    v_mov_b32 v140, v228
    v_mov_b32 v141, v229
    v_mov_b32 v142, v230
    v_mov_b32 v143, v231
    s_branch Lp2_63
Lp2_61:
    v_mov_b32 v136, v232
    v_mov_b32 v137, v233
    v_mov_b32 v138, v234
    v_mov_b32 v139, v235
    v_mov_b32 v140, v236
    v_mov_b32 v141, v237
    v_mov_b32 v142, v238
    v_mov_b32 v143, v239
Lp2_63:
    s_nop 1
    v_mfma_f32_16x16x32_bf16 v[144:147], v[136:139], v[96:99], 0
    v_mfma_f32_16x16x32_bf16 v[148:151], v[136:139], v[100:103], 0
    v_mfma_f32_16x16x32_bf16 v[152:155], v[136:139], v[104:107], 0
    v_mfma_f32_16x16x32_bf16 v[156:159], v[136:139], v[108:111], 0
    v_mfma_f32_16x16x32_bf16 v[160:163], v[136:139], v[112:115], 0
    v_mfma_f32_16x16x32_bf16 v[164:167], v[136:139], v[116:119], 0
    v_mfma_f32_16x16x32_bf16 v[168:171], v[136:139], v[120:123], 0
    v_mfma_f32_16x16x32_bf16 v[172:175], v[136:139], v[124:127], 0
    v_mfma_f32_16x16x32_bf16 v[144:147], v[140:143], v[32:35], v[144:147]
    v_mfma_f32_16x16x32_bf16 v[148:151], v[140:143], v[36:39], v[148:151]
    v_mfma_f32_16x16x32_bf16 v[152:155], v[140:143], v[40:43], v[152:155]
    v_mfma_f32_16x16x32_bf16 v[156:159], v[140:143], v[44:47], v[156:159]
    v_mfma_f32_16x16x32_bf16 v[160:163], v[140:143], v[48:51], v[160:163]
    v_mfma_f32_16x16x32_bf16 v[164:167], v[140:143], v[52:55], v[164:167]
    v_mfma_f32_16x16x32_bf16 v[168:171], v[140:143], v[56:59], v[168:171]
    v_mfma_f32_16x16x32_bf16 v[172:175], v[140:143], v[60:63], v[172:175]
    s_nop 7
    v_cndmask_b32 v176, v144, v161, s[46:47]
    v_cndmask_b32 v180, v160, v145, s[46:47]
    v_cndmask_b32 v177, v148, v165, s[46:47]
    v_cndmask_b32 v181, v164, v149, s[46:47]
    v_cndmask_b32 v178, v152, v169, s[46:47]
    v_cndmask_b32 v182, v168, v153, s[46:47]
    v_cndmask_b32 v179, v156, v173, s[46:47]
    v_cndmask_b32 v183, v172, v157, s[46:47]
    s_nop 0
    v_add_f32_dpp v176, v180, v176 row_ror:8 row_mask:0xf bank_mask:0xf
    v_add_f32_dpp v177, v181, v177 row_ror:8 row_mask:0xf bank_mask:0xf
    v_add_f32_dpp v178, v182, v178 row_ror:8 row_mask:0xf bank_mask:0xf
    v_add_f32_dpp v179, v183, v179 row_ror:8 row_mask:0xf bank_mask:0xf
    ds_write_b128 v18, v[176:179]
    s_waitcnt lgkmcnt(0)
    s_barrier
    s_cmp_lg_u32 s3, 0
    s_cbranch_scc1 L_done
    ds_read_b128 v[184:187], v8 offset:0
    ds_read_b128 v[188:191], v8 offset:1024
    ds_read_b128 v[192:195], v8 offset:2048
    ds_read_b128 v[196:199], v8 offset:3072
    ds_read_b128 v[200:203], v8 offset:4096
    ds_read_b128 v[204:207], v8 offset:5120
    ds_read_b128 v[208:211], v8 offset:6144
    ds_read_b128 v[212:215], v8 offset:7168
    s_waitcnt lgkmcnt(0)
    v_pk_add_f32 v[184:185], v[184:185], v[200:201]
    v_pk_add_f32 v[186:187], v[186:187], v[202:203]
    v_pk_add_f32 v[188:189], v[188:189], v[204:205]
    v_pk_add_f32 v[190:191], v[190:191], v[206:207]
    v_pk_add_f32 v[192:193], v[192:193], v[208:209]
    v_pk_add_f32 v[194:195], v[194:195], v[210:211]
    v_pk_add_f32 v[196:197], v[196:197], v[212:213]
    v_pk_add_f32 v[198:199], v[198:199], v[214:215]
    v_pk_add_f32 v[184:185], v[184:185], v[192:193]
    v_pk_add_f32 v[186:187], v[186:187], v[194:195]
    v_pk_add_f32 v[188:189], v[188:189], v[196:197]
    v_pk_add_f32 v[190:191], v[190:191], v[198:199]
    v_pk_add_f32 v[184:185], v[184:185], v[188:189]
    v_pk_add_f32 v[186:187], v[186:187], v[190:191]
    v_pk_mul_f32 v[184:185], v[184:185], v[132:133]
    v_pk_mul_f32 v[186:187], v[186:187], v[134:135]
    v_cvt_pk_bf16_f32 v184, v184, v185
    v_cvt_pk_bf16_f32 v185, v186, v187
    v_min_u32 v184, -2, v184
    v_min_u32 v185, -2, v185
    buffer_store_dwordx2 v[184:185], v19, s[48:51], s13 offen sc1
    s_branch L_done
LT6_47:
    s_mov_b32 s60, s32
    s_and_b32 s61, s33, 0xffff
    s_mov_b32 s62, 2211840
    s_mov_b32 s63, 0x20000
    v_bfe_u32 v11, v1, 3, 1
    v_lshlrev_b32 v11, 2, v11
    v_add_u32 v11, v11, v3
    s_mov_b32 s10, 27648
    v_mul_lo_u32 v10, s10, v11
    v_and_b32 v11, 7, v1
    v_lshl_add_u32 v10, v11, 4, v10
    s_mul_i32 s8, s3, 221184
    s_lshl_b32 s9, s14, 7
    s_add_u32 s8, s8, s9
    s_add_u32 s9, s8, 0
    buffer_load_dwordx4 v[64:67], v10, s[60:63], s9 offen nt
    s_add_u32 s9, s8, 3456
    buffer_load_dwordx4 v[68:71], v10, s[60:63], s9 offen nt
    s_add_u32 s9, s8, 6912
    buffer_load_dwordx4 v[72:75], v10, s[60:63], s9 offen nt
    s_add_u32 s9, s8, 10368
    buffer_load_dwordx4 v[76:79], v10, s[60:63], s9 offen nt
    s_add_u32 s9, s8, 13824
    buffer_load_dwordx4 v[80:83], v10, s[60:63], s9 offen nt
    s_add_u32 s9, s8, 17280
    buffer_load_dwordx4 v[84:87], v10, s[60:63], s9 offen nt
    s_add_u32 s9, s8, 20736
    buffer_load_dwordx4 v[88:91], v10, s[60:63], s9 offen nt
    s_add_u32 s9, s8, 24192
    buffer_load_dwordx4 v[92:95], v10, s[60:63], s9 offen nt
    v_bfe_u32 v16, v1, 3, 1
    v_lshlrev_b32 v16, 2, v16
    v_add_u32 v16, v16, v3
    s_mov_b32 s10, 1024
    v_mul_lo_u32 v15, s10, v16
    v_and_b32 v16, 7, v1
    v_lshl_add_u32 v15, v16, 4, v15
    s_lshl_b32 s9, s3, 13
    s_add_u32 s9, s9, 45056
    v_add_u32 v15, s9, v15
    s_waitcnt vmcnt(8)
    s_barrier
    ds_read_b128 v[32:35], v15 offset:0
    ds_read_b128 v[36:39], v15 offset:128
    ds_read_b128 v[40:43], v15 offset:256
    ds_read_b128 v[44:47], v15 offset:384
    ds_read_b128 v[48:51], v15 offset:512
    ds_read_b128 v[52:55], v15 offset:640
    ds_read_b128 v[56:59], v15 offset:768
    ds_read_b128 v[60:63], v15 offset:896
    s_cmp_ge_u32 s3, 2
    s_cbranch_scc1 L_64
    v_add_u32 v15, 0x10000, v15
    ds_read_b128 v[96:99], v15 offset:0
    ds_read_b128 v[100:103], v15 offset:128
    ds_read_b128 v[104:107], v15 offset:256
    ds_read_b128 v[108:111], v15 offset:384
    ds_read_b128 v[112:115], v15 offset:512
    ds_read_b128 v[116:119], v15 offset:640
    ds_read_b128 v[120:123], v15 offset:768
    ds_read_b128 v[124:127], v15 offset:896
    s_branch L_65
L_64:
    s_cmp_ge_u32 s3, 4
    s_cbranch_scc1 L_65
    s_add_u32 s9, s8, 1327104
    buffer_load_dwordx4 v[96:99], v10, s[60:63], s9 offen nt
    s_add_u32 s9, s8, 1330560
    buffer_load_dwordx4 v[100:103], v10, s[60:63], s9 offen nt
    s_add_u32 s9, s8, 1334016
    buffer_load_dwordx4 v[104:107], v10, s[60:63], s9 offen nt
    s_add_u32 s9, s8, 1337472
    buffer_load_dwordx4 v[108:111], v10, s[60:63], s9 offen nt
    s_add_u32 s9, s8, 1340928
    buffer_load_dwordx4 v[112:115], v10, s[60:63], s9 offen nt
    s_add_u32 s9, s8, 1344384
    buffer_load_dwordx4 v[116:119], v10, s[60:63], s9 offen nt
    s_add_u32 s9, s8, 1347840
    buffer_load_dwordx4 v[120:123], v10, s[60:63], s9 offen nt
    s_add_u32 s9, s8, 1351296
    buffer_load_dwordx4 v[124:127], v10, s[60:63], s9 offen nt
L_65:
    s_mov_b32 s64, s34
    s_and_b32 s65, s35, 0xffff
    s_mov_b32 s66, 2211840
    s_mov_b32 s67, 0x20000
    s_mov_b32 s68, s16
    s_and_b32 s69, s17, 0xffff
    s_mov_b32 s70, 5120
    s_mov_b32 s71, 0x20000
    v_bfe_u32 v12, v1, 3, 1
    v_lshlrev_b32 v12, 2, v12
    v_add_u32 v12, v12, v3
    s_mov_b32 s10, 10240
    v_mul_lo_u32 v11, s10, v12
    v_and_b32 v12, 7, v1
    v_lshl_add_u32 v11, v12, 4, v11
    s_mul_i32 s8, s14, 81920
    s_lshl_b32 s9, s3, 7
    s_add_u32 s8, s8, s9
    s_add_u32 s9, s8, 0
    buffer_load_dwordx4 v[128:131], v11, s[64:67], s9 offen nt
    s_add_u32 s9, s8, 1280
    buffer_load_dwordx4 v[132:135], v11, s[64:67], s9 offen nt
    s_add_u32 s9, s8, 2560
    buffer_load_dwordx4 v[136:139], v11, s[64:67], s9 offen nt
    s_add_u32 s9, s8, 3840
    buffer_load_dwordx4 v[140:143], v11, s[64:67], s9 offen nt
    s_add_u32 s9, s8, 5120
    buffer_load_dwordx4 v[144:147], v11, s[64:67], s9 offen nt
    s_add_u32 s9, s8, 6400
    buffer_load_dwordx4 v[148:151], v11, s[64:67], s9 offen nt
    s_add_u32 s9, s8, 7680
    buffer_load_dwordx4 v[152:155], v11, s[64:67], s9 offen nt
    s_add_u32 s9, s8, 8960
    buffer_load_dwordx4 v[156:159], v11, s[64:67], s9 offen nt
    s_cmp_lt_u32 s3, 4
    s_cbranch_scc1 L_66
    s_cmp_ge_u32 s3, 6
    s_cbranch_scc1 L_66
    s_add_u32 s9, s8, 512
    buffer_load_dwordx4 v[96:99], v11, s[64:67], s9 offen nt
    s_add_u32 s9, s8, 1792
    buffer_load_dwordx4 v[100:103], v11, s[64:67], s9 offen nt
    s_add_u32 s9, s8, 3072
    buffer_load_dwordx4 v[104:107], v11, s[64:67], s9 offen nt
    s_add_u32 s9, s8, 4352
    buffer_load_dwordx4 v[108:111], v11, s[64:67], s9 offen nt
    s_add_u32 s9, s8, 5632
    buffer_load_dwordx4 v[112:115], v11, s[64:67], s9 offen nt
    s_add_u32 s9, s8, 6912
    buffer_load_dwordx4 v[116:119], v11, s[64:67], s9 offen nt
    s_add_u32 s9, s8, 8192
    buffer_load_dwordx4 v[120:123], v11, s[64:67], s9 offen nt
    s_add_u32 s9, s8, 9472
    buffer_load_dwordx4 v[124:127], v11, s[64:67], s9 offen nt
L_66:
    s_movk_i32 s10, 1280
    v_mul_lo_u32 v12, s10, v3
    v_add_u32 v12, v12, v9
    s_lshl_b32 s15, s3, 8
    buffer_load_dwordx4 v[224:227], v12, s[68:71], s15 offen
    s_movk_i32 s10, 7680
    v_mul_lo_u32 v11, s10, v3
    v_add_u32 v11, v11, v9
    s_add_u32 s8, s15, 5120
    v_bfe_u32 v14, v1, 2, 2
    s_movk_i32 s10, 7680
    v_mul_lo_u32 v14, v14, s10
    v_and_b32 v15, 1, v1
    v_lshl_add_u32 v14, v15, 6, v14
    v_lshl_add_u32 v14, v3, 4, v14
    v_bfe_u32 v15, v1, 1, 1
    v_xor_b32 v15, 1, v15
    s_movk_i32 s10, 1280
    v_mul_lo_u32 v15, v15, s10
    v_add_u32 v14, v14, v15
    s_lshl_b32 s9, s3, 7
    s_add_u32 s9, s9, 3840
    s_cmp_lg_u32 s3, 0
    s_cbranch_scc1 L_68
L_68:
    s_barrier
    s_and_b32 s64, s3, 1
    s_lshl_b32 s64, s64, 7
    s_add_u32 s64, s64, 4864
Lpoll_69:
    s_sub_u32 s74, s74, 1
    s_cbranch_scc1 L_fail
    buffer_load_dwordx4 v[232:235], v14, s[48:51], s9 offen sc1
    buffer_load_dwordx4 v[236:239], v14, s[48:51], s64 offen sc1
    s_waitcnt vmcnt(0)
    v_max3_u32 v15, v232, v233, v234
    v_max3_u32 v15, v15, v235, v236
    v_max3_u32 v15, v15, v237, v238
    v_max_u32 v15, v15, v239
    v_cmp_eq_u32 vcc, -1, v15
    s_cbranch_vccz Lok_70
    s_sleep 8
    s_branch Lpoll_69
Lok_70:
    s_cmp_ge_u32 s3, 5
    s_cbranch_scc1 L_71
Lpoll_72:
    s_sub_u32 s74, s74, 1
    s_cbranch_scc1 L_fail
    buffer_load_dwordx4 v[228:231], v11, s[48:51], s8 offen sc1
    s_waitcnt vmcnt(0)
    v_max3_u32 v15, v228, v229, v230
    v_max_u32 v15, v15, v231
    v_cmp_eq_u32 vcc, -1, v15
    s_cbranch_vccz Lok_73
    s_sleep 8
    s_branch Lpoll_72
Lok_73:
L_71:
    s_waitcnt lgkmcnt(0)
    v_perm_b32 v192, v36, v32, s72
    v_perm_b32 v193, v44, v40, s72
    v_perm_b32 v194, v52, v48, s72
    v_perm_b32 v195, v60, v56, s72
    v_perm_b32 v196, v36, v32, s73
    v_perm_b32 v197, v44, v40, s73
    v_perm_b32 v198, v52, v48, s73
    v_perm_b32 v199, v60, v56, s73
    v_perm_b32 v200, v37, v33, s72
    v_perm_b32 v201, v45, v41, s72
    v_perm_b32 v202, v53, v49, s72
    v_perm_b32 v203, v61, v57, s72
    v_perm_b32 v204, v37, v33, s73
    v_perm_b32 v205, v45, v41, s73
    v_perm_b32 v206, v53, v49, s73
    v_perm_b32 v207, v61, v57, s73
    v_perm_b32 v208, v38, v34, s72
    v_perm_b32 v209, v46, v42, s72
    v_perm_b32 v210, v54, v50, s72
    v_perm_b32 v211, v62, v58, s72
    v_perm_b32 v212, v38, v34, s73
    v_perm_b32 v213, v46, v42, s73
    v_perm_b32 v214, v54, v50, s73
    v_perm_b32 v215, v62, v58, s73
    v_perm_b32 v216, v39, v35, s72
    v_perm_b32 v217, v47, v43, s72
    v_perm_b32 v218, v55, v51, s72
    v_perm_b32 v219, v63, v59, s72
    v_perm_b32 v220, v39, v35, s73
    v_perm_b32 v221, v47, v43, s73
    v_perm_b32 v222, v55, v51, s73
    v_perm_b32 v223, v63, v59, s73
    v_perm_b32 v32, v68, v64, s72
    v_perm_b32 v33, v76, v72, s72
    v_perm_b32 v34, v84, v80, s72
    v_perm_b32 v35, v92, v88, s72
    v_perm_b32 v36, v68, v64, s73
    v_perm_b32 v37, v76, v72, s73
    v_perm_b32 v38, v84, v80, s73
    v_perm_b32 v39, v92, v88, s73
    v_perm_b32 v40, v69, v65, s72
    v_perm_b32 v41, v77, v73, s72
    v_perm_b32 v42, v85, v81, s72
    v_perm_b32 v43, v93, v89, s72
    v_perm_b32 v44, v69, v65, s73
    v_perm_b32 v45, v77, v73, s73
    v_perm_b32 v46, v85, v81, s73
    v_perm_b32 v47, v93, v89, s73
    v_perm_b32 v48, v70, v66, s72
    v_perm_b32 v49, v78, v74, s72
    v_perm_b32 v50, v86, v82, s72
    v_perm_b32 v51, v94, v90, s72
    v_perm_b32 v52, v70, v66, s73
    v_perm_b32 v53, v78, v74, s73
    v_perm_b32 v54, v86, v82, s73
    v_perm_b32 v55, v94, v90, s73
    v_perm_b32 v56, v71, v67, s72
    v_perm_b32 v57, v79, v75, s72
    v_perm_b32 v58, v87, v83, s72
    v_perm_b32 v59, v95, v91, s72
    v_perm_b32 v60, v71, v67, s73
    v_perm_b32 v61, v79, v75, s73
    v_perm_b32 v62, v87, v83, s73
    v_perm_b32 v63, v95, v91, s73
    s_cmp_ge_u32 s3, 6
    s_cbranch_scc1 L_74
    v_perm_b32 v64, v100, v96, s72
    v_perm_b32 v65, v108, v104, s72
    v_perm_b32 v66, v116, v112, s72
    v_perm_b32 v67, v124, v120, s72
    v_perm_b32 v68, v100, v96, s73
    v_perm_b32 v69, v108, v104, s73
    v_perm_b32 v70, v116, v112, s73
    v_perm_b32 v71, v124, v120, s73
    v_perm_b32 v72, v101, v97, s72
    v_perm_b32 v73, v109, v105, s72
    v_perm_b32 v74, v117, v113, s72
    v_perm_b32 v75, v125, v121, s72
    v_perm_b32 v76, v101, v97, s73
    v_perm_b32 v77, v109, v105, s73
    v_perm_b32 v78, v117, v113, s73
    v_perm_b32 v79, v125, v121, s73
    v_perm_b32 v80, v102, v98, s72
    v_perm_b32 v81, v110, v106, s72
    v_perm_b32 v82, v118, v114, s72
    v_perm_b32 v83, v126, v122, s72
    v_perm_b32 v84, v102, v98, s73
    v_perm_b32 v85, v110, v106, s73
    v_perm_b32 v86, v118, v114, s73
    v_perm_b32 v87, v126, v122, s73
    v_perm_b32 v88, v103, v99, s72
    v_perm_b32 v89, v111, v107, s72
    v_perm_b32 v90, v119, v115, s72
    v_perm_b32 v91, v127, v123, s72
    v_perm_b32 v92, v103, v99, s73
    v_perm_b32 v93, v111, v107, s73
    v_perm_b32 v94, v119, v115, s73
    v_perm_b32 v95, v127, v123, s73
L_74:
    v_perm_b32 v96, v132, v128, s72
    v_perm_b32 v97, v140, v136, s72
    v_perm_b32 v98, v148, v144, s72
    v_perm_b32 v99, v156, v152, s72
    v_perm_b32 v100, v132, v128, s73
    v_perm_b32 v101, v140, v136, s73
    v_perm_b32 v102, v148, v144, s73
    v_perm_b32 v103, v156, v152, s73
    v_perm_b32 v104, v133, v129, s72
    v_perm_b32 v105, v141, v137, s72
    v_perm_b32 v106, v149, v145, s72
    v_perm_b32 v107, v157, v153, s72
    v_perm_b32 v108, v133, v129, s73
    v_perm_b32 v109, v141, v137, s73
    v_perm_b32 v110, v149, v145, s73
    v_perm_b32 v111, v157, v153, s73
    v_perm_b32 v112, v134, v130, s72
    v_perm_b32 v113, v142, v138, s72
    v_perm_b32 v114, v150, v146, s72
    v_perm_b32 v115, v158, v154, s72
    v_perm_b32 v116, v134, v130, s73
    v_perm_b32 v117, v142, v138, s73
    v_perm_b32 v118, v150, v146, s73
    v_perm_b32 v119, v158, v154, s73
    v_perm_b32 v120, v135, v131, s72
    v_perm_b32 v121, v143, v139, s72
    v_perm_b32 v122, v151, v147, s72
    v_perm_b32 v123, v159, v155, s72
    v_perm_b32 v124, v135, v131, s73
    v_perm_b32 v125, v143, v139, s73
    v_perm_b32 v126, v151, v147, s73
    v_perm_b32 v127, v159, v155, s73
    s_nop 1
    v_mfma_f32_16x16x32_bf16 v[128:131], v[232:235], v[192:195], 0
    v_mfma_f32_16x16x32_bf16 v[132:135], v[232:235], v[196:199], 0
    v_mfma_f32_16x16x32_bf16 v[136:139], v[232:235], v[200:203], 0
    v_mfma_f32_16x16x32_bf16 v[140:143], v[232:235], v[204:207], 0
    v_mfma_f32_16x16x32_bf16 v[144:147], v[232:235], v[208:211], 0
    v_mfma_f32_16x16x32_bf16 v[148:151], v[232:235], v[212:215], 0
    v_mfma_f32_16x16x32_bf16 v[152:155], v[232:235], v[216:219], 0
    v_mfma_f32_16x16x32_bf16 v[156:159], v[232:235], v[220:223], 0
    v_mfma_f32_16x16x32_bf16 v[160:163], v[232:235], v[32:35], 0
    v_mfma_f32_16x16x32_bf16 v[164:167], v[232:235], v[36:39], 0
    v_mfma_f32_16x16x32_bf16 v[168:171], v[232:235], v[40:43], 0
    v_mfma_f32_16x16x32_bf16 v[172:175], v[232:235], v[44:47], 0
    v_mfma_f32_16x16x32_bf16 v[176:179], v[232:235], v[48:51], 0
    v_mfma_f32_16x16x32_bf16 v[180:183], v[232:235], v[52:55], 0
    v_mfma_f32_16x16x32_bf16 v[184:187], v[232:235], v[56:59], 0
    v_mfma_f32_16x16x32_bf16 v[188:191], v[232:235], v[60:63], 0
    s_cmp_ge_u32 s3, 2
    s_cbranch_scc1 L_75
    v_mfma_f32_16x16x32_bf16 v[128:131], v[236:239], v[64:67], v[128:131]
    v_mfma_f32_16x16x32_bf16 v[132:135], v[236:239], v[68:71], v[132:135]
    v_mfma_f32_16x16x32_bf16 v[136:139], v[236:239], v[72:75], v[136:139]
    v_mfma_f32_16x16x32_bf16 v[140:143], v[236:239], v[76:79], v[140:143]
    v_mfma_f32_16x16x32_bf16 v[144:147], v[236:239], v[80:83], v[144:147]
    v_mfma_f32_16x16x32_bf16 v[148:151], v[236:239], v[84:87], v[148:151]
    v_mfma_f32_16x16x32_bf16 v[152:155], v[236:239], v[88:91], v[152:155]
    v_mfma_f32_16x16x32_bf16 v[156:159], v[236:239], v[92:95], v[156:159]
    s_branch L_76
L_75:
    s_cmp_ge_u32 s3, 4
    s_cbranch_scc1 L_76
    v_mfma_f32_16x16x32_bf16 v[160:163], v[236:239], v[64:67], v[160:163]
    v_mfma_f32_16x16x32_bf16 v[164:167], v[236:239], v[68:71], v[164:167]
    v_mfma_f32_16x16x32_bf16 v[168:171], v[236:239], v[72:75], v[168:171]
    v_mfma_f32_16x16x32_bf16 v[172:175], v[236:239], v[76:79], v[172:175]
    v_mfma_f32_16x16x32_bf16 v[176:179], v[236:239], v[80:83], v[176:179]
    v_mfma_f32_16x16x32_bf16 v[180:183], v[236:239], v[84:87], v[180:183]
    v_mfma_f32_16x16x32_bf16 v[184:187], v[236:239], v[88:91], v[184:187]
    v_mfma_f32_16x16x32_bf16 v[188:191], v[236:239], v[92:95], v[188:191]
L_76:
    s_lshl_b32 s11, s3, 12
    v_add_u32 v18, s11, v8
    s_nop 5
    v_cndmask_b32 v240, v128, v145, s[46:47]
    v_cndmask_b32 v244, v144, v129, s[46:47]
    v_cndmask_b32 v241, v132, v149, s[46:47]
    v_cndmask_b32 v245, v148, v133, s[46:47]
    v_cndmask_b32 v242, v136, v153, s[46:47]
    v_cndmask_b32 v246, v152, v137, s[46:47]
    v_cndmask_b32 v243, v140, v157, s[46:47]
    v_cndmask_b32 v247, v156, v141, s[46:47]
    s_nop 0
    v_add_f32_dpp v240, v244, v240 row_ror:8 row_mask:0xf bank_mask:0xf
    v_add_f32_dpp v241, v245, v241 row_ror:8 row_mask:0xf bank_mask:0xf
    v_add_f32_dpp v242, v246, v242 row_ror:8 row_mask:0xf bank_mask:0xf
    v_add_f32_dpp v243, v247, v243 row_ror:8 row_mask:0xf bank_mask:0xf
    ds_write_b128 v18, v[240:243]
    v_cndmask_b32 v248, v130, v147, s[46:47]
    v_cndmask_b32 v244, v146, v131, s[46:47]
    v_cndmask_b32 v249, v134, v151, s[46:47]
    v_cndmask_b32 v245, v150, v135, s[46:47]
    v_cndmask_b32 v250, v138, v155, s[46:47]
    v_cndmask_b32 v246, v154, v139, s[46:47]
    v_cndmask_b32 v251, v142, v159, s[46:47]
    v_cndmask_b32 v247, v158, v143, s[46:47]
    s_nop 0
    v_add_f32_dpp v248, v244, v248 row_ror:8 row_mask:0xf bank_mask:0xf
    v_add_f32_dpp v249, v245, v249 row_ror:8 row_mask:0xf bank_mask:0xf
    v_add_f32_dpp v250, v246, v250 row_ror:8 row_mask:0xf bank_mask:0xf
    v_add_f32_dpp v251, v247, v251 row_ror:8 row_mask:0xf bank_mask:0xf
    ds_write_b128 v18, v[248:251] offset:1024
    v_cndmask_b32 v240, v160, v177, s[46:47]
    v_cndmask_b32 v244, v176, v161, s[46:47]
    v_cndmask_b32 v241, v164, v181, s[46:47]
    v_cndmask_b32 v245, v180, v165, s[46:47]
    v_cndmask_b32 v242, v168, v185, s[46:47]
    v_cndmask_b32 v246, v184, v169, s[46:47]
    v_cndmask_b32 v243, v172, v189, s[46:47]
    v_cndmask_b32 v247, v188, v173, s[46:47]
    s_nop 0
    v_add_f32_dpp v240, v244, v240 row_ror:8 row_mask:0xf bank_mask:0xf
    v_add_f32_dpp v241, v245, v241 row_ror:8 row_mask:0xf bank_mask:0xf
    v_add_f32_dpp v242, v246, v242 row_ror:8 row_mask:0xf bank_mask:0xf
    v_add_f32_dpp v243, v247, v243 row_ror:8 row_mask:0xf bank_mask:0xf
    ds_write_b128 v18, v[240:243] offset:2048
    v_cndmask_b32 v248, v162, v179, s[46:47]
    v_cndmask_b32 v244, v178, v163, s[46:47]
    v_cndmask_b32 v249, v166, v183, s[46:47]
    v_cndmask_b32 v245, v182, v167, s[46:47]
    v_cndmask_b32 v250, v170, v187, s[46:47]
    v_cndmask_b32 v246, v186, v171, s[46:47]
    v_cndmask_b32 v251, v174, v191, s[46:47]
    v_cndmask_b32 v247, v190, v175, s[46:47]
    s_nop 0
    v_add_f32_dpp v248, v244, v248 row_ror:8 row_mask:0xf bank_mask:0xf
    v_add_f32_dpp v249, v245, v249 row_ror:8 row_mask:0xf bank_mask:0xf
    v_add_f32_dpp v250, v246, v250 row_ror:8 row_mask:0xf bank_mask:0xf
    v_add_f32_dpp v251, v247, v251 row_ror:8 row_mask:0xf bank_mask:0xf
    ds_write_b128 v18, v[248:251] offset:3072
    s_waitcnt lgkmcnt(0)
    s_barrier
    s_cmp_lg_u32 s3, 0
    s_cbranch_scc1 L_77
    ds_read_b128 v[128:131], v8 offset:0
    ds_read_b128 v[132:135], v8 offset:4096
    ds_read_b128 v[136:139], v8 offset:8192
    ds_read_b128 v[140:143], v8 offset:12288
    ds_read_b128 v[144:147], v8 offset:16384
    ds_read_b128 v[148:151], v8 offset:20480
    ds_read_b128 v[152:155], v8 offset:24576
    ds_read_b128 v[156:159], v8 offset:28672
    s_waitcnt lgkmcnt(0)
    v_pk_add_f32 v[128:129], v[128:129], v[144:145]
    v_pk_add_f32 v[130:131], v[130:131], v[146:147]
    v_pk_add_f32 v[132:133], v[132:133], v[148:149]
    v_pk_add_f32 v[134:135], v[134:135], v[150:151]
    v_pk_add_f32 v[136:137], v[136:137], v[152:153]
    v_pk_add_f32 v[138:139], v[138:139], v[154:155]
    v_pk_add_f32 v[140:141], v[140:141], v[156:157]
    v_pk_add_f32 v[142:143], v[142:143], v[158:159]
    v_pk_add_f32 v[128:129], v[128:129], v[136:137]
    v_pk_add_f32 v[130:131], v[130:131], v[138:139]
    v_pk_add_f32 v[132:133], v[132:133], v[140:141]
    v_pk_add_f32 v[134:135], v[134:135], v[142:143]
    v_pk_add_f32 v[16:17], v[128:129], v[132:133]
    v_pk_add_f32 v[18:19], v[130:131], v[134:135]
    ds_read_b128 v[128:131], v8 offset:1024
    ds_read_b128 v[132:135], v8 offset:5120
    ds_read_b128 v[136:139], v8 offset:9216
    ds_read_b128 v[140:143], v8 offset:13312
    ds_read_b128 v[144:147], v8 offset:17408
    ds_read_b128 v[148:151], v8 offset:21504
    ds_read_b128 v[152:155], v8 offset:25600
    ds_read_b128 v[156:159], v8 offset:29696
    s_waitcnt lgkmcnt(0)
    v_pk_add_f32 v[128:129], v[128:129], v[144:145]
    v_pk_add_f32 v[130:131], v[130:131], v[146:147]
    v_pk_add_f32 v[132:133], v[132:133], v[148:149]
    v_pk_add_f32 v[134:135], v[134:135], v[150:151]
    v_pk_add_f32 v[136:137], v[136:137], v[152:153]
    v_pk_add_f32 v[138:139], v[138:139], v[154:155]
    v_pk_add_f32 v[140:141], v[140:141], v[156:157]
    v_pk_add_f32 v[142:143], v[142:143], v[158:159]
    v_pk_add_f32 v[128:129], v[128:129], v[136:137]
    v_pk_add_f32 v[130:131], v[130:131], v[138:139]
    v_pk_add_f32 v[132:133], v[132:133], v[140:141]
    v_pk_add_f32 v[134:135], v[134:135], v[142:143]
    v_pk_add_f32 v[20:21], v[128:129], v[132:133]
    v_pk_add_f32 v[22:23], v[130:131], v[134:135]
    ds_read_b128 v[128:131], v8 offset:2048
    ds_read_b128 v[132:135], v8 offset:6144
    ds_read_b128 v[136:139], v8 offset:10240
    ds_read_b128 v[140:143], v8 offset:14336
    ds_read_b128 v[144:147], v8 offset:18432
    ds_read_b128 v[148:151], v8 offset:22528
    ds_read_b128 v[152:155], v8 offset:26624
    ds_read_b128 v[156:159], v8 offset:30720
    s_waitcnt lgkmcnt(0)
    v_pk_add_f32 v[128:129], v[128:129], v[144:145]
    v_pk_add_f32 v[130:131], v[130:131], v[146:147]
    v_pk_add_f32 v[132:133], v[132:133], v[148:149]
    v_pk_add_f32 v[134:135], v[134:135], v[150:151]
    v_pk_add_f32 v[136:137], v[136:137], v[152:153]
    v_pk_add_f32 v[138:139], v[138:139], v[154:155]
    v_pk_add_f32 v[140:141], v[140:141], v[156:157]
    v_pk_add_f32 v[142:143], v[142:143], v[158:159]
    v_pk_add_f32 v[128:129], v[128:129], v[136:137]
    v_pk_add_f32 v[130:131], v[130:131], v[138:139]
    v_pk_add_f32 v[132:133], v[132:133], v[140:141]
    v_pk_add_f32 v[134:135], v[134:135], v[142:143]
    v_pk_add_f32 v[24:25], v[128:129], v[132:133]
    v_pk_add_f32 v[26:27], v[130:131], v[134:135]
    ds_read_b128 v[128:131], v8 offset:3072
    ds_read_b128 v[132:135], v8 offset:7168
    ds_read_b128 v[136:139], v8 offset:11264
    ds_read_b128 v[140:143], v8 offset:15360
    ds_read_b128 v[144:147], v8 offset:19456
    ds_read_b128 v[148:151], v8 offset:23552
    ds_read_b128 v[152:155], v8 offset:27648
    ds_read_b128 v[156:159], v8 offset:31744
    s_waitcnt lgkmcnt(0)
    v_pk_add_f32 v[128:129], v[128:129], v[144:145]
    v_pk_add_f32 v[130:131], v[130:131], v[146:147]
    v_pk_add_f32 v[132:133], v[132:133], v[148:149]
    v_pk_add_f32 v[134:135], v[134:135], v[150:151]
    v_pk_add_f32 v[136:137], v[136:137], v[152:153]
    v_pk_add_f32 v[138:139], v[138:139], v[154:155]
    v_pk_add_f32 v[140:141], v[140:141], v[156:157]
    v_pk_add_f32 v[142:143], v[142:143], v[158:159]
    v_pk_add_f32 v[128:129], v[128:129], v[136:137]
    v_pk_add_f32 v[130:131], v[130:131], v[138:139]
    v_pk_add_f32 v[132:133], v[132:133], v[140:141]
    v_pk_add_f32 v[134:135], v[134:135], v[142:143]
    v_pk_add_f32 v[28:29], v[128:129], v[132:133]
    v_pk_add_f32 v[30:31], v[130:131], v[134:135]
L_77:
    s_barrier
    v_lshlrev_b32 v232, 16, v224
    v_and_b32 v233, 0xffff0000, v224
    v_lshlrev_b32 v240, 16, v228
    v_and_b32 v241, 0xffff0000, v228
    v_lshlrev_b32 v234, 16, v225
    v_and_b32 v235, 0xffff0000, v225
    v_lshlrev_b32 v242, 16, v229
    v_and_b32 v243, 0xffff0000, v229
    v_lshlrev_b32 v236, 16, v226
    v_and_b32 v237, 0xffff0000, v226
    v_lshlrev_b32 v244, 16, v230
    v_and_b32 v245, 0xffff0000, v230
    v_lshlrev_b32 v238, 16, v227
    v_and_b32 v239, 0xffff0000, v227
    v_lshlrev_b32 v246, 16, v231
    v_and_b32 v247, 0xffff0000, v231
    s_add_u32 s64, s15, 229376
    s_add_u32 s65, s15, 234496
    s_add_u32 s66, s15, 239616
    s_add_u32 s67, s15, 244736
    s_movk_i32 s10, 1344
    v_mul_lo_u32 v14, s10, v3
    v_add_u32 v14, v14, v9
    v_add_u32 v14, s15, v14
    v_lshlrev_b32 v15, 3, v3
    s_lshl_b32 s10, s3, 5
    v_add_u32 v15, s10, v15
    v_bfe_u32 v11, v1, 2, 2
    s_movk_i32 s10, 1344
    v_mul_lo_u32 v11, v11, s10
    v_and_b32 v10, 1, v1
    v_lshl_add_u32 v11, v10, 6, v11
    v_lshl_add_u32 v11, v3, 4, v11
    s_lshl_b32 s10, s3, 7
    v_add_u32 v10, s10, v11
    s_and_b32 s10, s3, 1
    s_lshl_b32 s10, s10, 7
    v_add_u32 v11, s10, v11
    s_cmp_ge_u32 s3, 5
    s_cbranch_scc1 Lskip_78
    buffer_load_dwordx4 v[128:131], v12, s[48:51], s64 offen sc1
    buffer_load_dwordx4 v[132:135], v12, s[48:51], s65 offen sc1
    buffer_load_dwordx4 v[136:139], v12, s[48:51], s66 offen sc1
    buffer_load_dwordx4 v[140:143], v12, s[48:51], s67 offen sc1
    s_sleep 3
    buffer_load_dwordx4 v[160:163], v12, s[48:51], s64 offen sc1
    buffer_load_dwordx4 v[164:167], v12, s[48:51], s65 offen sc1
    buffer_load_dwordx4 v[168:171], v12, s[48:51], s66 offen sc1
    buffer_load_dwordx4 v[172:175], v12, s[48:51], s67 offen sc1
Lp2_79:
    s_waitcnt vmcnt(4)
    v_max3_u32 v146, v128, v129, v130
    v_max3_u32 v146, v146, v131, v132
    v_max3_u32 v146, v146, v133, v134
    v_max3_u32 v146, v146, v135, v136
    v_max3_u32 v146, v146, v137, v138
    v_max3_u32 v146, v146, v139, v140
    v_max3_u32 v146, v146, v141, v142
    v_max_u32 v146, v146, v143
    v_cmp_eq_u32 vcc, -1, v146
    s_cbranch_vccz Lp2_80
    buffer_load_dwordx4 v[128:131], v12, s[48:51], s64 offen sc1
    buffer_load_dwordx4 v[132:135], v12, s[48:51], s65 offen sc1
    buffer_load_dwordx4 v[136:139], v12, s[48:51], s66 offen sc1
    buffer_load_dwordx4 v[140:143], v12, s[48:51], s67 offen sc1
    s_waitcnt vmcnt(4)
    v_max3_u32 v146, v160, v161, v162
    v_max3_u32 v146, v146, v163, v164
    v_max3_u32 v146, v146, v165, v166
    v_max3_u32 v146, v146, v167, v168
    v_max3_u32 v146, v146, v169, v170
    v_max3_u32 v146, v146, v171, v172
    v_max3_u32 v146, v146, v173, v174
    v_max_u32 v146, v146, v175
    v_cmp_eq_u32 vcc, -1, v146
    s_cbranch_vccz Lp2_81
    s_sub_u32 s74, s74, 1
    s_cbranch_scc1 L_fail
    buffer_load_dwordx4 v[160:163], v12, s[48:51], s64 offen sc1
    buffer_load_dwordx4 v[164:167], v12, s[48:51], s65 offen sc1
    buffer_load_dwordx4 v[168:171], v12, s[48:51], s66 offen sc1
    buffer_load_dwordx4 v[172:175], v12, s[48:51], s67 offen sc1
    s_branch Lp2_79
Lp2_81:
    v_mov_b32 v128, v160
    v_mov_b32 v129, v161
    v_mov_b32 v130, v162
    v_mov_b32 v131, v163
    v_mov_b32 v132, v164
    v_mov_b32 v133, v165
    v_mov_b32 v134, v166
    v_mov_b32 v135, v167
    v_mov_b32 v136, v168
    v_mov_b32 v137, v169
    v_mov_b32 v138, v170
    v_mov_b32 v139, v171
    v_mov_b32 v140, v172
    v_mov_b32 v141, v173
    v_mov_b32 v142, v174
    v_mov_b32 v143, v175
    s_branch Lp2_82
Lp2_80:
Lp2_82:
    s_nop 1
    v_lshlrev_b32 v144, 16, v128
    v_and_b32 v145, 0xffff0000, v128
    v_pk_add_f32 v[232:233], v[232:233], v[144:145]
    v_lshlrev_b32 v144, 16, v129
    v_and_b32 v145, 0xffff0000, v129
    v_pk_add_f32 v[234:235], v[234:235], v[144:145]
    v_lshlrev_b32 v144, 16, v130
    v_and_b32 v145, 0xffff0000, v130
    v_pk_add_f32 v[236:237], v[236:237], v[144:145]
    v_lshlrev_b32 v144, 16, v131
    v_and_b32 v145, 0xffff0000, v131
    v_pk_add_f32 v[238:239], v[238:239], v[144:145]
    v_lshlrev_b32 v144, 16, v132
    v_and_b32 v145, 0xffff0000, v132
    v_pk_add_f32 v[232:233], v[232:233], v[144:145]
    v_lshlrev_b32 v144, 16, v133
    v_and_b32 v145, 0xffff0000, v133
    v_pk_add_f32 v[234:235], v[234:235], v[144:145]
    v_lshlrev_b32 v144, 16, v134
    v_and_b32 v145, 0xffff0000, v134
    v_pk_add_f32 v[236:237], v[236:237], v[144:145]
    v_lshlrev_b32 v144, 16, v135
    v_and_b32 v145, 0xffff0000, v135
    v_pk_add_f32 v[238:239], v[238:239], v[144:145]
    v_lshlrev_b32 v144, 16, v136
    v_and_b32 v145, 0xffff0000, v136
    v_pk_add_f32 v[232:233], v[232:233], v[144:145]
    v_lshlrev_b32 v144, 16, v137
    v_and_b32 v145, 0xffff0000, v137
    v_pk_add_f32 v[234:235], v[234:235], v[144:145]
    v_lshlrev_b32 v144, 16, v138
    v_and_b32 v145, 0xffff0000, v138
    v_pk_add_f32 v[236:237], v[236:237], v[144:145]
    v_lshlrev_b32 v144, 16, v139
    v_and_b32 v145, 0xffff0000, v139
    v_pk_add_f32 v[238:239], v[238:239], v[144:145]
    v_lshlrev_b32 v144, 16, v140
    v_and_b32 v145, 0xffff0000, v140
    v_pk_add_f32 v[232:233], v[232:233], v[144:145]
    v_lshlrev_b32 v144, 16, v141
    v_and_b32 v145, 0xffff0000, v141
    v_pk_add_f32 v[234:235], v[234:235], v[144:145]
    v_lshlrev_b32 v144, 16, v142
    v_and_b32 v145, 0xffff0000, v142
    v_pk_add_f32 v[236:237], v[236:237], v[144:145]
    v_lshlrev_b32 v144, 16, v143
    v_and_b32 v145, 0xffff0000, v143
    v_pk_add_f32 v[238:239], v[238:239], v[144:145]
    v_pk_mul_f32 v[144:145], v[232:233], v[240:241]
    v_cvt_pk_bf16_f32 v148, v144, v145
    v_pk_mul_f32 v[144:145], v[234:235], v[242:243]
    v_cvt_pk_bf16_f32 v149, v144, v145
    v_pk_mul_f32 v[144:145], v[236:237], v[244:245]
    v_cvt_pk_bf16_f32 v150, v144, v145
    v_pk_mul_f32 v[144:145], v[238:239], v[246:247]
    v_cvt_pk_bf16_f32 v151, v144, v145
    ds_write_b128 v14, v[148:151] offset:32768
    v_mov_b32 v240, v232
    v_mov_b32 v241, v233
    v_mov_b32 v242, v234
    v_mov_b32 v243, v235
    v_mov_b32 v244, v236
    v_mov_b32 v245, v237
    v_mov_b32 v246, v238
    v_mov_b32 v247, v239
Lskip_78:
    s_waitcnt vmcnt(0) lgkmcnt(0)
    s_barrier
    ds_read_b128 v[232:235], v10 offset:32768
    ds_read_b128 v[236:239], v11 offset:33792
    s_lshl_b32 s11, s3, 11
    v_add_u32 v14, s11, v8
    s_waitcnt lgkmcnt(0)
    v_mfma_f32_16x16x32_bf16 v[128:131], v[232:235], v[192:195], 0
    v_mfma_f32_16x16x32_bf16 v[132:135], v[232:235], v[196:199], 0
    v_mfma_f32_16x16x32_bf16 v[136:139], v[232:235], v[200:203], 0
    v_mfma_f32_16x16x32_bf16 v[140:143], v[232:235], v[204:207], 0
    v_mfma_f32_16x16x32_bf16 v[144:147], v[232:235], v[208:211], 0
    v_mfma_f32_16x16x32_bf16 v[148:151], v[232:235], v[212:215], 0
    v_mfma_f32_16x16x32_bf16 v[152:155], v[232:235], v[216:219], 0
    v_mfma_f32_16x16x32_bf16 v[156:159], v[232:235], v[220:223], 0
    v_mfma_f32_16x16x32_bf16 v[160:163], v[232:235], v[32:35], 0
    v_mfma_f32_16x16x32_bf16 v[164:167], v[232:235], v[36:39], 0
    v_mfma_f32_16x16x32_bf16 v[168:171], v[232:235], v[40:43], 0
    v_mfma_f32_16x16x32_bf16 v[172:175], v[232:235], v[44:47], 0
    v_mfma_f32_16x16x32_bf16 v[176:179], v[232:235], v[48:51], 0
    v_mfma_f32_16x16x32_bf16 v[180:183], v[232:235], v[52:55], 0
    v_mfma_f32_16x16x32_bf16 v[184:187], v[232:235], v[56:59], 0
    v_mfma_f32_16x16x32_bf16 v[188:191], v[232:235], v[60:63], 0
    s_cmp_ge_u32 s3, 2
    s_cbranch_scc1 L_83
    v_mfma_f32_16x16x32_bf16 v[128:131], v[236:239], v[64:67], v[128:131]
    v_mfma_f32_16x16x32_bf16 v[132:135], v[236:239], v[68:71], v[132:135]
    v_mfma_f32_16x16x32_bf16 v[136:139], v[236:239], v[72:75], v[136:139]
    v_mfma_f32_16x16x32_bf16 v[140:143], v[236:239], v[76:79], v[140:143]
    v_mfma_f32_16x16x32_bf16 v[144:147], v[236:239], v[80:83], v[144:147]
    v_mfma_f32_16x16x32_bf16 v[148:151], v[236:239], v[84:87], v[148:151]
    v_mfma_f32_16x16x32_bf16 v[152:155], v[236:239], v[88:91], v[152:155]
    v_mfma_f32_16x16x32_bf16 v[156:159], v[236:239], v[92:95], v[156:159]
    s_branch L_84
L_83:
    s_cmp_ge_u32 s3, 4
    s_cbranch_scc1 L_84
    v_mfma_f32_16x16x32_bf16 v[160:163], v[236:239], v[64:67], v[160:163]
    v_mfma_f32_16x16x32_bf16 v[164:167], v[236:239], v[68:71], v[164:167]
    v_mfma_f32_16x16x32_bf16 v[168:171], v[236:239], v[72:75], v[168:171]
    v_mfma_f32_16x16x32_bf16 v[172:175], v[236:239], v[76:79], v[172:175]
    v_mfma_f32_16x16x32_bf16 v[176:179], v[236:239], v[80:83], v[176:179]
    v_mfma_f32_16x16x32_bf16 v[180:183], v[236:239], v[84:87], v[180:183]
    v_mfma_f32_16x16x32_bf16 v[184:187], v[236:239], v[88:91], v[184:187]
    v_mfma_f32_16x16x32_bf16 v[188:191], v[236:239], v[92:95], v[188:191]
L_84:
    s_cmp_ge_u32 s3, 5
    s_cbranch_scc1 Lsk2_85
    v_add_f32 v224, v240, v241
    v_mul_f32 v225, v240, v240
    v_fmac_f32 v225, v241, v241
    v_add_f32 v224, v224, v242
    v_fmac_f32 v225, v242, v242
    v_add_f32 v224, v224, v243
    v_fmac_f32 v225, v243, v243
    v_add_f32 v224, v224, v244
    v_fmac_f32 v225, v244, v244
    v_add_f32 v224, v224, v245
    v_fmac_f32 v225, v245, v245
    v_add_f32 v224, v224, v246
    v_fmac_f32 v225, v246, v246
    v_add_f32 v224, v224, v247
    v_fmac_f32 v225, v247, v247
    s_nop 1
    v_add_f32_dpp v224, v224, v224 quad_perm:[1,0,3,2] row_mask:0xf bank_mask:0xf
    s_nop 1
    v_add_f32_dpp v224, v224, v224 quad_perm:[2,3,0,1] row_mask:0xf bank_mask:0xf
    s_nop 1
    v_add_f32_dpp v224, v224, v224 row_half_mirror row_mask:0xf bank_mask:0xf
    s_nop 1
    v_add_f32_dpp v224, v224, v224 row_mirror row_mask:0xf bank_mask:0xf
    s_nop 1
    v_add_f32_dpp v225, v225, v225 quad_perm:[1,0,3,2] row_mask:0xf bank_mask:0xf
    s_nop 1
    v_add_f32_dpp v225, v225, v225 quad_perm:[2,3,0,1] row_mask:0xf bank_mask:0xf
    s_nop 1
    v_add_f32_dpp v225, v225, v225 row_half_mirror row_mask:0xf bank_mask:0xf
    s_nop 1
    v_add_f32_dpp v225, v225, v225 row_mirror row_mask:0xf bank_mask:0xf
    ds_write_b64 v15, v[224:225] offset:40960
Lsk2_85:
    s_nop 7
    v_cndmask_b32 v240, v128, v145, s[46:47]
    v_cndmask_b32 v244, v144, v129, s[46:47]
    v_cndmask_b32 v241, v132, v149, s[46:47]
    v_cndmask_b32 v245, v148, v133, s[46:47]
    v_cndmask_b32 v242, v136, v153, s[46:47]
    v_cndmask_b32 v246, v152, v137, s[46:47]
    v_cndmask_b32 v243, v140, v157, s[46:47]
    v_cndmask_b32 v247, v156, v141, s[46:47]
    s_nop 0
    v_add_f32_dpp v240, v244, v240 row_ror:8 row_mask:0xf bank_mask:0xf
    v_add_f32_dpp v241, v245, v241 row_ror:8 row_mask:0xf bank_mask:0xf
    v_add_f32_dpp v242, v246, v242 row_ror:8 row_mask:0xf bank_mask:0xf
    v_add_f32_dpp v243, v247, v243 row_ror:8 row_mask:0xf bank_mask:0xf
    ds_write_b128 v14, v[240:243]
    v_cndmask_b32 v248, v160, v177, s[46:47]
    v_cndmask_b32 v244, v176, v161, s[46:47]
    v_cndmask_b32 v249, v164, v181, s[46:47]
    v_cndmask_b32 v245, v180, v165, s[46:47]
    v_cndmask_b32 v250, v168, v185, s[46:47]
    v_cndmask_b32 v246, v184, v169, s[46:47]
    v_cndmask_b32 v251, v172, v189, s[46:47]
    v_cndmask_b32 v247, v188, v173, s[46:47]
    s_nop 0
    v_add_f32_dpp v248, v244, v248 row_ror:8 row_mask:0xf bank_mask:0xf
    v_add_f32_dpp v249, v245, v249 row_ror:8 row_mask:0xf bank_mask:0xf
    v_add_f32_dpp v250, v246, v250 row_ror:8 row_mask:0xf bank_mask:0xf
    v_add_f32_dpp v251, v247, v251 row_ror:8 row_mask:0xf bank_mask:0xf
    ds_write_b128 v14, v[248:251] offset:1024
    s_waitcnt lgkmcnt(0)
    s_barrier
    s_cmp_lg_u32 s3, 0
    s_cbranch_scc1 L_86
    ds_read_b128 v[128:131], v8 offset:0
    ds_read_b128 v[160:163], v8 offset:1024
    ds_read_b128 v[132:135], v8 offset:2048
    ds_read_b128 v[164:167], v8 offset:3072
    ds_read_b128 v[136:139], v8 offset:4096
    ds_read_b128 v[168:171], v8 offset:5120
    ds_read_b128 v[140:143], v8 offset:6144
    ds_read_b128 v[172:175], v8 offset:7168
    ds_read_b128 v[144:147], v8 offset:8192
    ds_read_b128 v[176:179], v8 offset:9216
    ds_read_b128 v[148:151], v8 offset:10240
    ds_read_b128 v[180:183], v8 offset:11264
    ds_read_b128 v[152:155], v8 offset:12288
    ds_read_b128 v[184:187], v8 offset:13312
    ds_read_b128 v[156:159], v8 offset:14336
    ds_read_b128 v[188:191], v8 offset:15360
    v_lshlrev_b32 v14, 3, v3
    ds_read_b64 v[224:225], v14 offset:40960
    ds_read_b64 v[226:227], v14 offset:40992
    ds_read_b64 v[228:229], v14 offset:41024
    ds_read_b64 v[230:231], v14 offset:41056
    ds_read_b64 v[232:233], v14 offset:41088
    s_movk_i32 s10, 192
    v_mul_lo_u32 v14, s10, v3
    v_and_b32 v15, 7, v2
    v_lshl_add_u32 v14, v15, 4, v14
    v_lshrrev_b32 v15, 3, v2
    v_lshl_add_u32 v14, v15, 3, v14
    s_waitcnt lgkmcnt(0)
    v_pk_add_f32 v[128:129], v[128:129], v[144:145]
    v_pk_add_f32 v[130:131], v[130:131], v[146:147]
    v_pk_add_f32 v[132:133], v[132:133], v[148:149]
    v_pk_add_f32 v[134:135], v[134:135], v[150:151]
    v_pk_add_f32 v[136:137], v[136:137], v[152:153]
    v_pk_add_f32 v[138:139], v[138:139], v[154:155]
    v_pk_add_f32 v[140:141], v[140:141], v[156:157]
    v_pk_add_f32 v[142:143], v[142:143], v[158:159]
    v_pk_add_f32 v[128:129], v[128:129], v[136:137]
    v_pk_add_f32 v[130:131], v[130:131], v[138:139]
    v_pk_add_f32 v[132:133], v[132:133], v[140:141]
    v_pk_add_f32 v[134:135], v[134:135], v[142:143]
    v_pk_add_f32 v[128:129], v[128:129], v[132:133]
    v_pk_add_f32 v[130:131], v[130:131], v[134:135]
    v_pk_add_f32 v[160:161], v[160:161], v[176:177]
    v_pk_add_f32 v[162:163], v[162:163], v[178:179]
    v_pk_add_f32 v[164:165], v[164:165], v[180:181]
    v_pk_add_f32 v[166:167], v[166:167], v[182:183]
    v_pk_add_f32 v[168:169], v[168:169], v[184:185]
    v_pk_add_f32 v[170:171], v[170:171], v[186:187]
    v_pk_add_f32 v[172:173], v[172:173], v[188:189]
    v_pk_add_f32 v[174:175], v[174:175], v[190:191]
    v_pk_add_f32 v[160:161], v[160:161], v[168:169]
    v_pk_add_f32 v[162:163], v[162:163], v[170:171]
    v_pk_add_f32 v[164:165], v[164:165], v[172:173]
    v_pk_add_f32 v[166:167], v[166:167], v[174:175]
    v_pk_add_f32 v[160:161], v[160:161], v[164:165]
    v_pk_add_f32 v[162:163], v[162:163], v[166:167]
    v_pk_add_f32 v[224:225], v[224:225], v[226:227]
    v_pk_add_f32 v[228:229], v[228:229], v[230:231]
    v_pk_add_f32 v[224:225], v[224:225], v[228:229]
    v_pk_add_f32 v[224:225], v[224:225], v[232:233]
    s_mov_b32 s10, 0x3acccccd
    v_mul_f32 v224, s10, v224
    v_mul_f32 v225, s10, v225
    v_fma_f32 v225, -v224, v224, v225
    v_max_f32 v225, 0, v225
    s_mov_b32 s11, 0x3727c5ac
    v_add_f32 v225, s11, v225
    v_rsq_f32 v225, v225
    s_mov_b32 s10, 0x3d372713
    s_mov_b32 s11, 0xc0135761
    v_fma_f32 v128, -v224, v16, v128
    v_fma_f32 v160, -v224, v24, v160
    v_fma_f32 v129, -v224, v17, v129
    v_fma_f32 v161, -v224, v25, v161
    v_fma_f32 v130, -v224, v18, v130
    v_fma_f32 v162, -v224, v26, v162
    v_fma_f32 v131, -v224, v19, v131
    v_fma_f32 v163, -v224, v27, v163
    v_fma_f32 v128, v128, v225, v20
    v_fma_f32 v160, v160, v225, v28
    v_fma_f32 v129, v129, v225, v21
    v_fma_f32 v161, v161, v225, v29
    v_fma_f32 v130, v130, v225, v22
    v_fma_f32 v162, v162, v225, v30
    v_fma_f32 v131, v131, v225, v23
    v_fma_f32 v163, v163, v225, v31
    v_mul_f32 v132, v128, v128
    v_mul_f32 v133, v129, v129
    v_mul_f32 v134, v130, v130
    v_mul_f32 v135, v131, v131
    v_fma_f32 v132, v132, s10, 1.0
    v_fma_f32 v133, v133, s10, 1.0
    v_fma_f32 v134, v134, s10, 1.0
    v_fma_f32 v135, v135, s10, 1.0
    v_mul_f32 v132, v132, v128
    v_mul_f32 v133, v133, v129
    v_mul_f32 v134, v134, v130
    v_mul_f32 v135, v135, v131
    v_mul_f32 v132, s11, v132
    v_mul_f32 v133, s11, v133
    v_mul_f32 v134, s11, v134
    v_mul_f32 v135, s11, v135
    v_exp_f32 v132, v132
    v_exp_f32 v133, v133
    v_exp_f32 v134, v134
    v_exp_f32 v135, v135
    v_add_f32 v132, 1.0, v132
    v_add_f32 v133, 1.0, v133
    v_add_f32 v134, 1.0, v134
    v_add_f32 v135, 1.0, v135
    v_rcp_f32 v132, v132
    v_rcp_f32 v133, v133
    v_rcp_f32 v134, v134
    v_rcp_f32 v135, v135
    v_mul_f32 v128, v128, v160
    v_mul_f32 v129, v129, v161
    v_mul_f32 v130, v130, v162
    v_mul_f32 v131, v131, v163
    v_mul_f32 v132, v132, v128
    v_mul_f32 v133, v133, v129
    v_mul_f32 v134, v134, v130
    v_mul_f32 v135, v135, v131
    v_cvt_pk_bf16_f32 v132, v132, v133
    v_cvt_pk_bf16_f32 v133, v134, v135
    ds_write_b64 v14, v[132:133] offset:41984
L_86:
    v_bfe_u32 v14, v1, 2, 2
    s_movk_i32 s10, 192
    v_mul_lo_u32 v14, v14, s10
    v_and_b32 v15, 1, v1
    v_lshl_add_u32 v14, v15, 6, v14
    v_lshl_add_u32 v14, v3, 4, v14
    s_movk_i32 s10, 1280
    v_mul_lo_u32 v15, s10, v3
    v_and_b32 v10, 7, v2
    v_lshl_add_u32 v15, v10, 4, v15
    v_lshrrev_b32 v10, 3, v2
    v_lshl_add_u32 v15, v10, 3, v15
    s_lshl_b32 s9, s3, 7
    s_add_u32 s9, s9, s13
    s_waitcnt lgkmcnt(0)
    s_barrier
    ds_read_b128 v[232:235], v14 offset:41984
    s_waitcnt lgkmcnt(0)
    v_mfma_f32_16x16x32_bf16 v[128:131], v[232:235], v[96:99], 0
    v_mfma_f32_16x16x32_bf16 v[132:135], v[232:235], v[100:103], 0
    v_mfma_f32_16x16x32_bf16 v[136:139], v[232:235], v[104:107], 0
    v_mfma_f32_16x16x32_bf16 v[140:143], v[232:235], v[108:111], 0
    v_mfma_f32_16x16x32_bf16 v[144:147], v[232:235], v[112:115], 0
    v_mfma_f32_16x16x32_bf16 v[148:151], v[232:235], v[116:119], 0
    v_mfma_f32_16x16x32_bf16 v[152:155], v[232:235], v[120:123], 0
    v_mfma_f32_16x16x32_bf16 v[156:159], v[232:235], v[124:127], 0
    s_nop 7
    v_cndmask_b32 v240, v128, v145, s[46:47]
    v_cndmask_b32 v244, v144, v129, s[46:47]
    v_cndmask_b32 v241, v132, v149, s[46:47]
    v_cndmask_b32 v245, v148, v133, s[46:47]
    v_cndmask_b32 v242, v136, v153, s[46:47]
    v_cndmask_b32 v246, v152, v137, s[46:47]
    v_cndmask_b32 v243, v140, v157, s[46:47]
    v_cndmask_b32 v247, v156, v141, s[46:47]
    s_nop 0
    v_add_f32_dpp v240, v244, v240 row_ror:8 row_mask:0xf bank_mask:0xf
    v_add_f32_dpp v241, v245, v241 row_ror:8 row_mask:0xf bank_mask:0xf
    v_add_f32_dpp v242, v246, v242 row_ror:8 row_mask:0xf bank_mask:0xf
    v_add_f32_dpp v243, v247, v243 row_ror:8 row_mask:0xf bank_mask:0xf
    v_cvt_pk_bf16_f32 v240, v240, v241
    v_cvt_pk_bf16_f32 v241, v242, v243
    v_min_u32 v240, -2, v240
    v_min_u32 v241, -2, v241
    buffer_store_dwordx2 v[240:241], v15, s[48:51], s9 offen offset:0 sc1
    s_cmp_lt_u32 s3, 4
    s_cbranch_scc1 L_done
    s_cmp_ge_u32 s3, 6
    s_cbranch_scc1 L_done
    s_nop 1
    v_mfma_f32_16x16x32_bf16 v[128:131], v[232:235], v[64:67], 0
    v_mfma_f32_16x16x32_bf16 v[132:135], v[232:235], v[68:71], 0
    v_mfma_f32_16x16x32_bf16 v[136:139], v[232:235], v[72:75], 0
    v_mfma_f32_16x16x32_bf16 v[140:143], v[232:235], v[76:79], 0
    v_mfma_f32_16x16x32_bf16 v[144:147], v[232:235], v[80:83], 0
    v_mfma_f32_16x16x32_bf16 v[148:151], v[232:235], v[84:87], 0
    v_mfma_f32_16x16x32_bf16 v[152:155], v[232:235], v[88:91], 0
    v_mfma_f32_16x16x32_bf16 v[156:159], v[232:235], v[92:95], 0
    s_nop 7
    v_cndmask_b32 v240, v128, v145, s[46:47]
    v_cndmask_b32 v244, v144, v129, s[46:47]
    v_cndmask_b32 v241, v132, v149, s[46:47]
    v_cndmask_b32 v245, v148, v133, s[46:47]
    v_cndmask_b32 v242, v136, v153, s[46:47]
    v_cndmask_b32 v246, v152, v137, s[46:47]
    v_cndmask_b32 v243, v140, v157, s[46:47]
    v_cndmask_b32 v247, v156, v141, s[46:47]
    s_nop 0
    v_add_f32_dpp v240, v244, v240 row_ror:8 row_mask:0xf bank_mask:0xf
    v_add_f32_dpp v241, v245, v241 row_ror:8 row_mask:0xf bank_mask:0xf
    v_add_f32_dpp v242, v246, v242 row_ror:8 row_mask:0xf bank_mask:0xf
    v_add_f32_dpp v243, v247, v243 row_ror:8 row_mask:0xf bank_mask:0xf
    v_cvt_pk_bf16_f32 v240, v240, v241
    v_cvt_pk_bf16_f32 v241, v242, v243
    v_min_u32 v240, -2, v240
    v_min_u32 v241, -2, v241
    buffer_store_dwordx2 v[240:241], v15, s[48:51], s9 offen offset:512 sc1
    s_branch L_done
L_roleE:
    s_and_b32 s4, s2, 7
    s_lshl_b32 s4, s4, 2
    s_bfe_u32 s5, s2, 0x20003
    s_or_b32 s4, s4, s5
    s_lshr_b32 s5, s2, 5
    s_cmp_lg_u32 s3, 7
    s_cbranch_scc1 L_89
    s_cmp_lg_u32 s2, 64
    s_cbranch_scc1 L_89
    s_memrealtime s[78:79]
    s_waitcnt lgkmcnt(0)
    s_or_b32 s78, s78, 1
    v_mov_b32 v14, s78
    v_mov_b32 v15, s79
    s_mov_b64 exec, 1
    buffer_store_dwordx2 v[14:15], off, s[52:55], 0 sc1
    buffer_store_dwordx2 v[14:15], off, s[52:55], 0 offset:128 sc1
    s_mov_b64 exec, -1
L_89:
    s_cmp_lg_u32 s3, 0
    s_cbranch_scc1 L_90
    buffer_load_dwordx2 v[20:21], off, s[52:55], 0 offset:128 sc1
L_90:
    s_mov_b32 s56, s20
    s_and_b32 s57, s21, 0xffff
    s_mov_b32 s58, 5242880
    s_mov_b32 s59, 0x20000
    v_lshlrev_b32 v11, 16, v3
    v_add_u32 v11, v11, v9
    s_mul_i32 s9, s5, 5
    s_add_u32 s14, s9, s3
    s_cmp_ge_u32 s3, 5
    s_cbranch_scc1 L_91
    s_lshl_b32 s11, s14, 18
    s_lshl_b32 s8, s4, 8
    s_add_u32 s11, s11, s8
    s_add_u32 s9, s11, 0
    buffer_load_dwordx4 v[32:35], v11, s[56:59], s9 offen nt
    s_add_u32 s9, s11, 8192
    buffer_load_dwordx4 v[36:39], v11, s[56:59], s9 offen nt
    s_add_u32 s9, s11, 16384
    buffer_load_dwordx4 v[40:43], v11, s[56:59], s9 offen nt
    s_add_u32 s9, s11, 24576
    buffer_load_dwordx4 v[44:47], v11, s[56:59], s9 offen nt
    s_add_u32 s9, s11, 32768
    buffer_load_dwordx4 v[48:51], v11, s[56:59], s9 offen nt
    s_add_u32 s9, s11, 40960
    buffer_load_dwordx4 v[52:55], v11, s[56:59], s9 offen nt
    s_add_u32 s9, s11, 49152
    buffer_load_dwordx4 v[56:59], v11, s[56:59], s9 offen nt
    s_add_u32 s9, s11, 57344
    buffer_load_dwordx4 v[60:63], v11, s[56:59], s9 offen nt
L_91:
    s_mov_b32 s60, s22
    s_and_b32 s61, s23, 0xffff
    s_mov_b32 s62, 4194304
    s_mov_b32 s63, 0x20000
    v_lshlrev_b32 v11, 13, v2
    v_lshl_add_u32 v11, v3, 4, v11
    s_lshl_b32 s9, s5, 7
    s_lshl_b32 s10, s3, 4
    s_add_u32 s9, s9, s10
    s_lshl_b32 s9, s9, 13
    s_lshl_b32 s10, s4, 8
    s_add_u32 s9, s9, s10
    buffer_load_dwordx4 v[160:163], v11, s[60:63], s9 offen offset:0 nt
    buffer_load_dwordx4 v[164:167], v11, s[60:63], s9 offen offset:64 nt
    buffer_load_dwordx4 v[168:171], v11, s[60:63], s9 offen offset:128 nt
    buffer_load_dwordx4 v[172:175], v11, s[60:63], s9 offen offset:192 nt
    s_cmp_lg_u32 s3, 7
    s_cbranch_scc1 L_92
    v_mov_b32 v16, 0
    v_mov_b32 v17, 20480
    ds_write_b32 v17, v16
L_92:
    v_lshlrev_b32 v10, 15, v3
    v_add_u32 v10, v10, v9
    s_lshl_b32 s6, s4, 10
    s_lshl_b32 s7, s5, 8
    s_add_u32 s6, s6, s7
    s_add_u32 s6, s6, 32768
    s_lshl_b32 s7, s5, 13
    s_lshl_b32 s8, s4, 8
    s_add_u32 s7, s7, s8
    s_add_u32 s7, s7, 163840
    v_bfe_u32 v14, v1, 2, 2
    s_movk_i32 s10, 2560
    v_mul_lo_u32 v14, v14, s10
    v_and_b32 v15, 1, v1
    v_xor_b32 v15, 1, v15
    s_movk_i32 s10, 1280
    v_mul_lo_u32 v15, v15, s10
    v_add_u32 v14, v14, v15
    v_lshl_add_u32 v14, v3, 4, v14
    v_add_u32 v18, 10240, v14
    s_and_b32 s15, s2, 7
    s_mul_i32 s15, s15, 20480
    s_add_u32 s15, s15, 524288
    s_lshl_b32 s14, s14, 6
    s_add_u32 s14, s14, s15
    v_lshlrev_b32 v19, 8, v3
    v_add_u32 v19, v19, v9
    s_lshl_b32 s66, s4, 2
    s_add_u32 s67, s66, s5
    s_lshl_b32 s67, s67, 10
    s_add_u32 s67, s67, 720896
    s_lshl_b32 s66, s66, 10
    s_add_u32 s66, s66, 720896
    s_waitcnt lgkmcnt(0)
    s_barrier
    s_waitcnt vmcnt(0)
    s_cmp_lg_u32 s3, 0
    s_cbranch_scc1 L_93
Lnn_94:
    v_readfirstlane_b32 s78, v20
    v_readfirstlane_b32 s79, v21
    s_cmp_lg_u32 s78, 0
    s_cbranch_scc1 Lnn_95
    s_sub_u32 s74, s74, 1
    s_cbranch_scc1 L_fail
    s_sleep 4
    buffer_load_dwordx2 v[20:21], off, s[52:55], 0 offset:128 sc1
    s_waitcnt vmcnt(0)
    s_branch Lnn_94
Lnn_95:
    v_mov_b32 v16, s78
    v_mov_b32 v17, 20480
    ds_write_b32 v17, v16
    v_lshlrev_b32 v22, 6, v1
    s_mov_b32 s10, 458752
    s_mov_b32 s11, 462848
    buffer_load_dwordx2 v[24:25], v22, s[48:51], s10 offen sc1
    buffer_load_dwordx2 v[26:27], v22, s[48:51], s11 offen sc1
L_93:
    s_cmp_ge_u32 s3, 5
    s_cbranch_scc1 L_96
    v_perm_b32 v128, v36, v32, s72
    v_perm_b32 v129, v44, v40, s72
    v_perm_b32 v130, v52, v48, s72
    v_perm_b32 v131, v60, v56, s72
    v_perm_b32 v132, v36, v32, s73
    v_perm_b32 v133, v44, v40, s73
    v_perm_b32 v134, v52, v48, s73
    v_perm_b32 v135, v60, v56, s73
    v_perm_b32 v136, v37, v33, s72
    v_perm_b32 v137, v45, v41, s72
    v_perm_b32 v138, v53, v49, s72
    v_perm_b32 v139, v61, v57, s72
    v_perm_b32 v140, v37, v33, s73
    v_perm_b32 v141, v45, v41, s73
    v_perm_b32 v142, v53, v49, s73
    v_perm_b32 v143, v61, v57, s73
    v_perm_b32 v144, v38, v34, s72
    v_perm_b32 v145, v46, v42, s72
    v_perm_b32 v146, v54, v50, s72
    v_perm_b32 v147, v62, v58, s72
    v_perm_b32 v148, v38, v34, s73
    v_perm_b32 v149, v46, v42, s73
    v_perm_b32 v150, v54, v50, s73
    v_perm_b32 v151, v62, v58, s73
    v_perm_b32 v152, v39, v35, s72
    v_perm_b32 v153, v47, v43, s72
    v_perm_b32 v154, v55, v51, s72
    v_perm_b32 v155, v63, v59, s72
    v_perm_b32 v156, v39, v35, s73
    v_perm_b32 v157, v47, v43, s73
    v_perm_b32 v158, v55, v51, s73
    v_perm_b32 v159, v63, v59, s73
L_96:
    v_mov_b32 v17, 20480
L_97:
    ds_read_b32 v16, v17
    s_waitcnt lgkmcnt(0)
    v_readfirstlane_b32 s78, v16
    s_cmp_eq_u32 s78, 0
    s_cbranch_scc1 L_97
    s_cmp_ge_u32 s3, 5
    s_cbranch_scc1 L_98
    buffer_load_dwordx4 v[232:235], v14, s[48:51], s14 offen sc1
    buffer_load_dwordx4 v[236:239], v18, s[48:51], s14 offen sc1
    s_sleep 3
    buffer_load_dwordx4 v[240:243], v14, s[48:51], s14 offen sc1
    buffer_load_dwordx4 v[244:247], v18, s[48:51], s14 offen sc1
Lp2_99:
    s_waitcnt vmcnt(2)
    v_xor_b32 v236, v236, v232
    v_xor_b32 v237, v237, v233
    v_xor_b32 v238, v238, v234
    v_xor_b32 v239, v239, v235
    v_xor_b32 v15, s78, v236
    v_xor_b32 v237, s78, v237
    v_xor_b32 v238, s78, v238
    v_xor_b32 v239, s78, v239
    v_or3_b32 v15, v15, v237, v238
    v_or_b32 v15, v15, v239
    v_cmp_ne_u32 vcc, 0, v15
    s_cbranch_vccz Lp2_100
    buffer_load_dwordx4 v[232:235], v14, s[48:51], s14 offen sc1
    buffer_load_dwordx4 v[236:239], v18, s[48:51], s14 offen sc1
    s_waitcnt vmcnt(2)
    v_xor_b32 v244, v244, v240
    v_xor_b32 v245, v245, v241
    v_xor_b32 v246, v246, v242
    v_xor_b32 v247, v247, v243
    v_xor_b32 v15, s78, v244
    v_xor_b32 v245, s78, v245
    v_xor_b32 v246, s78, v246
    v_xor_b32 v247, s78, v247
    v_or3_b32 v15, v15, v245, v246
    v_or_b32 v15, v15, v247
    v_cmp_ne_u32 vcc, 0, v15
    s_cbranch_vccz Lp2_101
    s_sub_u32 s74, s74, 1
    s_cbranch_scc1 L_fail
    buffer_load_dwordx4 v[240:243], v14, s[48:51], s14 offen sc1
    buffer_load_dwordx4 v[244:247], v18, s[48:51], s14 offen sc1
    s_branch Lp2_99
Lp2_101:
    v_mov_b32 v176, v240
    v_mov_b32 v177, v241
    v_mov_b32 v178, v242
    v_mov_b32 v179, v243
    s_branch Lp2_102
Lp2_100:
    v_mov_b32 v176, v232
    v_mov_b32 v177, v233
    v_mov_b32 v178, v234
    v_mov_b32 v179, v235
Lp2_102:
    s_nop 1
    v_mfma_f32_16x16x32_bf16 v[192:195], v[176:179], v[128:131], 0
    v_mfma_f32_16x16x32_bf16 v[196:199], v[176:179], v[132:135], 0
    v_mfma_f32_16x16x32_bf16 v[200:203], v[176:179], v[136:139], 0
    v_mfma_f32_16x16x32_bf16 v[204:207], v[176:179], v[140:143], 0
    v_mfma_f32_16x16x32_bf16 v[208:211], v[176:179], v[144:147], 0
    v_mfma_f32_16x16x32_bf16 v[212:215], v[176:179], v[148:151], 0
    v_mfma_f32_16x16x32_bf16 v[216:219], v[176:179], v[152:155], 0
    v_mfma_f32_16x16x32_bf16 v[220:223], v[176:179], v[156:159], 0
    s_lshl_b32 s11, s3, 11
    v_add_u32 v17, s11, v8
    s_nop 5
    v_add_f32 v224, v192, v193
    v_add_f32 v225, v196, v197
    v_add_f32 v226, v200, v201
    v_add_f32 v227, v204, v205
    v_add_f32 v228, v208, v209
    v_add_f32 v229, v212, v213
    v_add_f32 v230, v216, v217
    v_add_f32 v231, v220, v221
    ds_write_b128 v17, v[224:227]
    ds_write_b128 v17, v[228:231] offset:1024
L_98:
    s_waitcnt lgkmcnt(0)
    s_barrier
    s_cmp_lg_u32 s3, 0
    s_cbranch_scc1 L_103
    ds_read_b128 v[192:195], v8 offset:0
    ds_read_b128 v[196:199], v8 offset:1024
    ds_read_b128 v[200:203], v8 offset:2048
    ds_read_b128 v[204:207], v8 offset:3072
    ds_read_b128 v[208:211], v8 offset:4096
    ds_read_b128 v[212:215], v8 offset:5120
    ds_read_b128 v[216:219], v8 offset:6144
    ds_read_b128 v[220:223], v8 offset:7168
    ds_read_b128 v[224:227], v8 offset:8192
    ds_read_b128 v[228:231], v8 offset:9216
    v_lshlrev_b32 v22, 6, v1
    s_mov_b32 s10, 458752
    s_mov_b32 s11, 462848
    buffer_load_dwordx2 v[24:25], v22, s[48:51], s10 offen sc1
    buffer_load_dwordx2 v[26:27], v22, s[48:51], s11 offen sc1
    s_waitcnt lgkmcnt(0)
    v_pk_add_f32 v[192:193], v[192:193], v[200:201]
    v_pk_add_f32 v[208:209], v[208:209], v[216:217]
    v_pk_add_f32 v[194:195], v[194:195], v[202:203]
    v_pk_add_f32 v[210:211], v[210:211], v[218:219]
    v_pk_add_f32 v[196:197], v[196:197], v[204:205]
    v_pk_add_f32 v[212:213], v[212:213], v[220:221]
    v_pk_add_f32 v[198:199], v[198:199], v[206:207]
    v_pk_add_f32 v[214:215], v[214:215], v[222:223]
    v_pk_add_f32 v[192:193], v[192:193], v[224:225]
    v_pk_add_f32 v[194:195], v[194:195], v[226:227]
    v_pk_add_f32 v[196:197], v[196:197], v[228:229]
    v_pk_add_f32 v[198:199], v[198:199], v[230:231]
    v_pk_add_f32 v[192:193], v[192:193], v[208:209]
    v_pk_add_f32 v[194:195], v[194:195], v[210:211]
    v_pk_add_f32 v[196:197], v[196:197], v[212:213]
    v_pk_add_f32 v[198:199], v[198:199], v[214:215]
    v_cvt_pk_bf16_f32 v192, v192, v193
    v_cvt_pk_bf16_f32 v193, v194, v195
    v_cvt_pk_bf16_f32 v194, v196, v197
    v_cvt_pk_bf16_f32 v195, v198, v199
    v_xor_b32 v196, s78, v192
    v_xor_b32 v197, s78, v193
    v_xor_b32 v198, s78, v194
    v_xor_b32 v199, s78, v195
    s_add_u32 s10, s67, 131072
    buffer_store_dwordx4 v[192:195], v19, s[48:51], s67 offen sc1
    buffer_store_dwordx4 v[196:199], v19, s[48:51], s10 offen sc1
L_103:
    s_barrier
    s_cmp_ge_u32 s3, 4
    s_cbranch_scc1 L_104
    s_lshl_b32 s10, s3, 10
    s_add_u32 s10, s10, s66
    s_add_u32 s69, s10, 131072
    s_lshl_b32 s11, s3, 2
    v_add_u32 v17, s11, v3
    s_movk_i32 s11, 320
    v_mul_lo_u32 v17, v17, s11
    v_add_u32 v17, v17, v9
    buffer_load_dwordx4 v[232:235], v8, s[48:51], s10 offen sc1
    buffer_load_dwordx4 v[236:239], v8, s[48:51], s69 offen sc1
    s_sleep 3
    buffer_load_dwordx4 v[240:243], v8, s[48:51], s10 offen sc1
    buffer_load_dwordx4 v[244:247], v8, s[48:51], s69 offen sc1
Lp2_105:
    s_waitcnt vmcnt(2)
    v_xor_b32 v236, v236, v232
    v_xor_b32 v237, v237, v233
    v_xor_b32 v238, v238, v234
    v_xor_b32 v239, v239, v235
    v_xor_b32 v15, s78, v236
    v_xor_b32 v237, s78, v237
    v_xor_b32 v238, s78, v238
    v_xor_b32 v239, s78, v239
    v_or3_b32 v15, v15, v237, v238
    v_or_b32 v15, v15, v239
    v_cmp_ne_u32 vcc, 0, v15
    s_cbranch_vccz Lp2_106
    buffer_load_dwordx4 v[232:235], v8, s[48:51], s10 offen sc1
    buffer_load_dwordx4 v[236:239], v8, s[48:51], s69 offen sc1
    s_waitcnt vmcnt(2)
    v_xor_b32 v244, v244, v240
    v_xor_b32 v245, v245, v241
    v_xor_b32 v246, v246, v242
    v_xor_b32 v247, v247, v243
    v_xor_b32 v15, s78, v244
    v_xor_b32 v245, s78, v245
    v_xor_b32 v246, s78, v246
    v_xor_b32 v247, s78, v247
    v_or3_b32 v15, v15, v245, v246
    v_or_b32 v15, v15, v247
    v_cmp_ne_u32 vcc, 0, v15
    s_cbranch_vccz Lp2_107
    s_sub_u32 s74, s74, 1
    s_cbranch_scc1 L_fail
    buffer_load_dwordx4 v[240:243], v8, s[48:51], s10 offen sc1
    buffer_load_dwordx4 v[244:247], v8, s[48:51], s69 offen sc1
    s_branch Lp2_105
Lp2_107:
    v_mov_b32 v176, v240
    v_mov_b32 v177, v241
    v_mov_b32 v178, v242
    v_mov_b32 v179, v243
    s_branch Lp2_108
Lp2_106:
    v_mov_b32 v176, v232
    v_mov_b32 v177, v233
    v_mov_b32 v178, v234
    v_mov_b32 v179, v235
Lp2_108:
    s_nop 1
    ds_write_b128 v17, v[176:179] offset:24576
L_104:
    v_and_b32 v17, 15, v1
    v_and_b32 v15, 3, v17
    v_lshrrev_b32 v17, 2, v17
    v_lshl_add_u32 v17, v15, 2, v17
    s_movk_i32 s11, 320
    v_mul_lo_u32 v17, v17, s11
    v_lshl_add_u32 v17, v3, 4, v17
    s_waitcnt lgkmcnt(0)
    s_barrier
    ds_read_b128 v[176:179], v17 offset:24576
    ds_read_b128 v[180:183], v17 offset:24640
    ds_read_b128 v[184:187], v17 offset:24704
    ds_read_b128 v[188:191], v17 offset:24768
    s_waitcnt lgkmcnt(0)
    s_mov_b32 s11, 0x3e0293ee
    v_lshlrev_b32 v17, 8, v3
    v_lshl_add_u32 v17, v2, 1, v17
    s_lshl_b32 s10, s3, 5
    v_add_u32 v17, s10, v17
    v_mfma_f32_16x16x32_bf16 v[192:195], v[176:179], v[160:163], 0
    v_mfma_f32_16x16x32_bf16 v[192:195], v[180:183], v[164:167], v[192:195]
    v_mfma_f32_16x16x32_bf16 v[192:195], v[184:187], v[168:171], v[192:195]
    v_mfma_f32_16x16x32_bf16 v[192:195], v[188:191], v[172:175], v[192:195]
    s_nop 7
    v_add_f32 v192, v192, v193
    v_add_f32 v194, v194, v195
    v_add_f32 v192, v192, v194
    v_mul_f32 v192, s11, v192
    v_cvt_pk_bf16_f32 v192, v192, v192
    ds_write_b16 v17, v192 offset:18432
    s_waitcnt lgkmcnt(0)
    s_barrier
    s_cmp_lg_u32 s3, 0
    s_cbranch_scc1 L_109
    ds_read_b128 v[192:195], v8 offset:18432
Lcf_110:
    v_xor_b32 v24, s78, v24
    v_xor_b32 v25, s79, v25
    v_xor_b32 v26, s78, v26
    v_xor_b32 v27, s79, v27
    v_or3_b32 v24, v24, v25, v26
    v_or_b32 v24, v24, v27
    v_cmp_ne_u32 vcc, 0, v24
    s_cbranch_vccz Lcf_111
    s_sub_u32 s74, s74, 1
    s_cbranch_scc1 L_fail
    s_sleep 8
    v_lshlrev_b32 v22, 6, v1
    s_mov_b32 s10, 458752
    s_mov_b32 s11, 462848
    buffer_load_dwordx2 v[24:25], v22, s[48:51], s10 offen sc1
    buffer_load_dwordx2 v[26:27], v22, s[48:51], s11 offen sc1
    s_waitcnt vmcnt(0)
    s_branch Lcf_110
Lcf_111:
    s_waitcnt lgkmcnt(0)
    v_min_u32 v192, -2, v192
    v_min_u32 v193, -2, v193
    v_min_u32 v194, -2, v194
    v_min_u32 v195, -2, v195
    buffer_store_dwordx4 v[192:195], v10, s[48:51], s6 offen sc1
L_109:
    s_barrier
    s_mov_b32 s64, s24
    s_and_b32 s65, s25, 0xffff
    s_mov_b32 s66, 4194304
    s_mov_b32 s67, 0x20000
    v_lshlrev_b32 v11, 14, v3
    v_add_u32 v11, v11, v9
    s_lshl_b32 s14, s5, 1
    s_add_u32 s14, s14, s3
    s_and_b32 s14, s14, 7
    s_lshl_b32 s8, s4, 8
    s_lshl_b32 s9, s14, 19
    s_add_u32 s8, s8, s9
    s_add_u32 s9, s8, 0
    buffer_load_dwordx4 v[32:35], v11, s[64:67], s9 offen nt
    s_add_u32 s9, s8, 131072
    buffer_load_dwordx4 v[36:39], v11, s[64:67], s9 offen nt
    s_add_u32 s9, s8, 262144
    buffer_load_dwordx4 v[40:43], v11, s[64:67], s9 offen nt
    s_add_u32 s9, s8, 393216
    buffer_load_dwordx4 v[44:47], v11, s[64:67], s9 offen nt
    s_add_u32 s9, s8, 8192
    buffer_load_dwordx4 v[48:51], v11, s[64:67], s9 offen nt
    s_add_u32 s9, s8, 139264
    buffer_load_dwordx4 v[52:55], v11, s[64:67], s9 offen nt
    s_add_u32 s9, s8, 270336
    buffer_load_dwordx4 v[56:59], v11, s[64:67], s9 offen nt
    s_add_u32 s9, s8, 401408
    buffer_load_dwordx4 v[60:63], v11, s[64:67], s9 offen nt
    s_add_u32 s9, s8, 65536
    buffer_load_dwordx4 v[64:67], v11, s[64:67], s9 offen nt
    s_add_u32 s9, s8, 196608
    buffer_load_dwordx4 v[68:71], v11, s[64:67], s9 offen nt
    s_add_u32 s9, s8, 327680
    buffer_load_dwordx4 v[72:75], v11, s[64:67], s9 offen nt
    s_add_u32 s9, s8, 458752
    buffer_load_dwordx4 v[76:79], v11, s[64:67], s9 offen nt
    s_add_u32 s9, s8, 73728
    buffer_load_dwordx4 v[80:83], v11, s[64:67], s9 offen nt
    s_add_u32 s9, s8, 204800
    buffer_load_dwordx4 v[84:87], v11, s[64:67], s9 offen nt
    s_add_u32 s9, s8, 335872
    buffer_load_dwordx4 v[88:91], v11, s[64:67], s9 offen nt
    s_add_u32 s9, s8, 466944
    buffer_load_dwordx4 v[92:95], v11, s[64:67], s9 offen nt
    v_lshlrev_b32 v11, 10, v2
    v_lshl_add_u32 v11, v3, 4, v11
    s_lshl_b32 s8, s5, 5
    s_add_u32 s8, s8, s4
    s_lshl_b32 s8, s8, 15
    s_lshl_b32 s9, s14, 7
    s_add_u32 s8, s8, s9
    s_add_u32 s8, s8, 1048576
    s_add_u32 s9, s8, 16384
    v_and_b32 v14, 31, v1
    v_lshlrev_b32 v14, 7, v14
    s_lshl_b32 s15, s5, 5
    s_add_u32 s15, s15, s4
    s_lshl_b32 s15, s15, 12
    s_add_u32 s15, s15, 5242880
    s_waitcnt vmcnt(0)
    v_perm_b32 v128, v36, v32, s72
    v_perm_b32 v129, v44, v40, s72
    v_perm_b32 v130, v52, v48, s72
    v_perm_b32 v131, v60, v56, s72
    v_perm_b32 v132, v36, v32, s73
    v_perm_b32 v133, v44, v40, s73
    v_perm_b32 v134, v52, v48, s73
    v_perm_b32 v135, v60, v56, s73
    v_perm_b32 v136, v37, v33, s72
    v_perm_b32 v137, v45, v41, s72
    v_perm_b32 v138, v53, v49, s72
    v_perm_b32 v139, v61, v57, s72
    v_perm_b32 v140, v37, v33, s73
    v_perm_b32 v141, v45, v41, s73
    v_perm_b32 v142, v53, v49, s73
    v_perm_b32 v143, v61, v57, s73
    v_perm_b32 v144, v38, v34, s72
    v_perm_b32 v145, v46, v42, s72
    v_perm_b32 v146, v54, v50, s72
    v_perm_b32 v147, v62, v58, s72
    v_perm_b32 v148, v38, v34, s73
    v_perm_b32 v149, v46, v42, s73
    v_perm_b32 v150, v54, v50, s73
    v_perm_b32 v151, v62, v58, s73
    v_perm_b32 v152, v39, v35, s72
    v_perm_b32 v153, v47, v43, s72
    v_perm_b32 v154, v55, v51, s72
    v_perm_b32 v155, v63, v59, s72
    v_perm_b32 v156, v39, v35, s73
    v_perm_b32 v157, v47, v43, s73
    v_perm_b32 v158, v55, v51, s73
    v_perm_b32 v159, v63, v59, s73
    v_perm_b32 v32, v68, v64, s72
    v_perm_b32 v33, v76, v72, s72
    v_perm_b32 v34, v84, v80, s72
    v_perm_b32 v35, v92, v88, s72
    v_perm_b32 v36, v68, v64, s73
    v_perm_b32 v37, v76, v72, s73
    v_perm_b32 v38, v84, v80, s73
    v_perm_b32 v39, v92, v88, s73
    v_perm_b32 v40, v69, v65, s72
    v_perm_b32 v41, v77, v73, s72
    v_perm_b32 v42, v85, v81, s72
    v_perm_b32 v43, v93, v89, s72
    v_perm_b32 v44, v69, v65, s73
    v_perm_b32 v45, v77, v73, s73
    v_perm_b32 v46, v85, v81, s73
    v_perm_b32 v47, v93, v89, s73
    v_perm_b32 v48, v70, v66, s72
    v_perm_b32 v49, v78, v74, s72
    v_perm_b32 v50, v86, v82, s72
    v_perm_b32 v51, v94, v90, s72
    v_perm_b32 v52, v70, v66, s73
    v_perm_b32 v53, v78, v74, s73
    v_perm_b32 v54, v86, v82, s73
    v_perm_b32 v55, v94, v90, s73
    v_perm_b32 v56, v71, v67, s72
    v_perm_b32 v57, v79, v75, s72
    v_perm_b32 v58, v87, v83, s72
    v_perm_b32 v59, v95, v91, s72
    v_perm_b32 v60, v71, v67, s73
    v_perm_b32 v61, v79, v75, s73
    v_perm_b32 v62, v87, v83, s73
    v_perm_b32 v63, v95, v91, s73
    s_cmp_lg_u32 s3, 0
    s_cbranch_scc1 L_112
    buffer_load_dwordx4 v[180:183], v14, s[48:51], s15 offen sc1
    s_sleep 3
    buffer_load_dwordx4 v[184:187], v14, s[48:51], s15 offen sc1
Lp2_113:
    s_waitcnt vmcnt(1)
    v_xor_b32 v182, v182, v180
    v_xor_b32 v183, v183, v181
    v_xor_b32 v15, s78, v182
    v_xor_b32 v183, s78, v183
    v_or_b32 v15, v15, v183
    v_cmp_ne_u32 vcc, 0, v15
    s_cbranch_vccz Lp2_114
    s_sleep 2
    buffer_load_dwordx4 v[180:183], v14, s[48:51], s15 offen sc1
    s_waitcnt vmcnt(1)
    v_xor_b32 v186, v186, v184
    v_xor_b32 v187, v187, v185
    v_xor_b32 v15, s78, v186
    v_xor_b32 v187, s78, v187
    v_or_b32 v15, v15, v187
    v_cmp_ne_u32 vcc, 0, v15
    s_cbranch_vccz Lp2_115
    s_sub_u32 s74, s74, 1
    s_cbranch_scc1 L_fail
    s_sleep 2
    buffer_load_dwordx4 v[184:187], v14, s[48:51], s15 offen sc1
    s_branch Lp2_113
Lp2_115:
    v_mov_b32 v176, v184
    v_mov_b32 v177, v185
    s_branch Lp2_116
Lp2_114:
    v_mov_b32 v176, v180
    v_mov_b32 v177, v181
Lp2_116:
    s_nop 1
L_112:
    s_barrier
    buffer_load_dwordx4 v[160:163], v11, s[48:51], s8 offen offset:0 sc1
    buffer_load_dwordx4 v[164:167], v11, s[48:51], s8 offen offset:64 sc1
    buffer_load_dwordx4 v[168:171], v11, s[48:51], s9 offen offset:0 sc1
    buffer_load_dwordx4 v[172:175], v11, s[48:51], s9 offen offset:64 sc1
    s_waitcnt vmcnt(0)
    v_mfma_f32_16x16x32_bf16 v[192:195], v[160:163], v[128:131], 0
    v_mfma_f32_16x16x32_bf16 v[196:199], v[160:163], v[132:135], 0
    v_mfma_f32_16x16x32_bf16 v[200:203], v[160:163], v[136:139], 0
    v_mfma_f32_16x16x32_bf16 v[204:207], v[160:163], v[140:143], 0
    v_mfma_f32_16x16x32_bf16 v[208:211], v[160:163], v[144:147], 0
    v_mfma_f32_16x16x32_bf16 v[212:215], v[160:163], v[148:151], 0
    v_mfma_f32_16x16x32_bf16 v[216:219], v[160:163], v[152:155], 0
    v_mfma_f32_16x16x32_bf16 v[220:223], v[160:163], v[156:159], 0
    v_mfma_f32_16x16x32_bf16 v[224:227], v[168:171], v[128:131], 0
    v_mfma_f32_16x16x32_bf16 v[228:231], v[168:171], v[132:135], 0
    v_mfma_f32_16x16x32_bf16 v[232:235], v[168:171], v[136:139], 0
    v_mfma_f32_16x16x32_bf16 v[236:239], v[168:171], v[140:143], 0
    v_mfma_f32_16x16x32_bf16 v[240:243], v[168:171], v[144:147], 0
    v_mfma_f32_16x16x32_bf16 v[244:247], v[168:171], v[148:151], 0
    v_mfma_f32_16x16x32_bf16 v[248:251], v[168:171], v[152:155], 0
    v_mfma_f32_16x16x32_bf16 v[252:255], v[168:171], v[156:159], 0
    v_mfma_f32_16x16x32_bf16 v[192:195], v[164:167], v[32:35], v[192:195]
    v_mfma_f32_16x16x32_bf16 v[196:199], v[164:167], v[36:39], v[196:199]
    v_mfma_f32_16x16x32_bf16 v[200:203], v[164:167], v[40:43], v[200:203]
    v_mfma_f32_16x16x32_bf16 v[204:207], v[164:167], v[44:47], v[204:207]
    v_mfma_f32_16x16x32_bf16 v[208:211], v[164:167], v[48:51], v[208:211]
    v_mfma_f32_16x16x32_bf16 v[212:215], v[164:167], v[52:55], v[212:215]
    v_mfma_f32_16x16x32_bf16 v[216:219], v[164:167], v[56:59], v[216:219]
    v_mfma_f32_16x16x32_bf16 v[220:223], v[164:167], v[60:63], v[220:223]
    v_mfma_f32_16x16x32_bf16 v[224:227], v[172:175], v[32:35], v[224:227]
    v_mfma_f32_16x16x32_bf16 v[228:231], v[172:175], v[36:39], v[228:231]
    v_mfma_f32_16x16x32_bf16 v[232:235], v[172:175], v[40:43], v[232:235]
    v_mfma_f32_16x16x32_bf16 v[236:239], v[172:175], v[44:47], v[236:239]
    v_mfma_f32_16x16x32_bf16 v[240:243], v[172:175], v[48:51], v[240:243]
    v_mfma_f32_16x16x32_bf16 v[244:247], v[172:175], v[52:55], v[244:247]
    v_mfma_f32_16x16x32_bf16 v[248:251], v[172:175], v[56:59], v[248:251]
    v_mfma_f32_16x16x32_bf16 v[252:255], v[172:175], v[60:63], v[252:255]
    s_cmp_lg_u32 s3, 0
    s_cbranch_scc1 L_117
    v_mov_b32 v178, v176
    s_nop 1
    v_max_f32_dpp v178, v178, v178 quad_perm:[1,0,3,2] row_mask:0xf bank_mask:0xf
    s_nop 1
    v_max_f32_dpp v178, v178, v178 quad_perm:[2,3,0,1] row_mask:0xf bank_mask:0xf
    s_nop 1
    v_max_f32_dpp v178, v178, v178 row_half_mirror row_mask:0xf bank_mask:0xf
    s_nop 1
    v_max_f32_dpp v178, v178, v178 row_mirror row_mask:0xf bank_mask:0xf
    v_mov_b32 v179, v178
    s_nop 1
    v_permlane16_swap_b32 v178, v179
    s_nop 1
    v_max_f32 v178, v178, v179
    v_sub_f32 v178, v176, v178
    v_exp_f32 v178, v178
    s_nop 0
    v_mul_f32 v179, v178, v177
    s_nop 1
    v_add_f32_dpp v179, v179, v179 quad_perm:[1,0,3,2] row_mask:0xf bank_mask:0xf
    s_nop 1
    v_add_f32_dpp v179, v179, v179 quad_perm:[2,3,0,1] row_mask:0xf bank_mask:0xf
    s_nop 1
    v_add_f32_dpp v179, v179, v179 row_half_mirror row_mask:0xf bank_mask:0xf
    s_nop 1
    v_add_f32_dpp v179, v179, v179 row_mirror row_mask:0xf bank_mask:0xf
    v_mov_b32 v180, v179
    s_nop 1
    v_permlane16_swap_b32 v179, v180
    s_nop 1
    v_add_f32 v179, v179, v180
    v_rcp_f32 v179, v179
    s_nop 0
    v_mul_f32 v178, v178, v179
    v_and_b32 v15, 31, v1
    v_lshlrev_b32 v15, 2, v15
    ds_write_b32 v15, v178 offset:8192
L_117:
    v_lshlrev_b32 v15, 4, v3
    s_waitcnt lgkmcnt(0)
    s_barrier
    ds_read_b128 v[180:183], v15 offset:8192
    ds_read_b128 v[184:187], v15 offset:8256
    v_lshlrev_b32 v16, 5, v2
    v_lshl_add_u32 v16, v3, 3, v16
    s_lshl_b32 s11, s3, 9
    v_add_u32 v16, s11, v16
    s_waitcnt lgkmcnt(0)
    s_nop 3
    v_pk_mul_f32 v[96:97], v[192:193], v[180:181]
    v_pk_fma_f32 v[96:97], v[194:195], v[182:183], v[96:97]
    v_pk_mul_f32 v[98:99], v[196:197], v[180:181]
    v_pk_fma_f32 v[98:99], v[198:199], v[182:183], v[98:99]
    v_pk_mul_f32 v[100:101], v[200:201], v[180:181]
    v_pk_fma_f32 v[100:101], v[202:203], v[182:183], v[100:101]
    v_pk_mul_f32 v[102:103], v[204:205], v[180:181]
    v_pk_fma_f32 v[102:103], v[206:207], v[182:183], v[102:103]
    v_pk_mul_f32 v[104:105], v[208:209], v[180:181]
    v_pk_fma_f32 v[104:105], v[210:211], v[182:183], v[104:105]
    v_pk_mul_f32 v[106:107], v[212:213], v[180:181]
    v_pk_fma_f32 v[106:107], v[214:215], v[182:183], v[106:107]
    v_pk_mul_f32 v[108:109], v[216:217], v[180:181]
    v_pk_fma_f32 v[108:109], v[218:219], v[182:183], v[108:109]
    v_pk_mul_f32 v[110:111], v[220:221], v[180:181]
    v_pk_fma_f32 v[110:111], v[222:223], v[182:183], v[110:111]
    v_pk_fma_f32 v[96:97], v[224:225], v[184:185], v[96:97]
    v_pk_fma_f32 v[96:97], v[226:227], v[186:187], v[96:97]
    v_pk_fma_f32 v[98:99], v[228:229], v[184:185], v[98:99]
    v_pk_fma_f32 v[98:99], v[230:231], v[186:187], v[98:99]
    v_pk_fma_f32 v[100:101], v[232:233], v[184:185], v[100:101]
    v_pk_fma_f32 v[100:101], v[234:235], v[186:187], v[100:101]
    v_pk_fma_f32 v[102:103], v[236:237], v[184:185], v[102:103]
    v_pk_fma_f32 v[102:103], v[238:239], v[186:187], v[102:103]
    v_pk_fma_f32 v[104:105], v[240:241], v[184:185], v[104:105]
    v_pk_fma_f32 v[104:105], v[242:243], v[186:187], v[104:105]
    v_pk_fma_f32 v[106:107], v[244:245], v[184:185], v[106:107]
    v_pk_fma_f32 v[106:107], v[246:247], v[186:187], v[106:107]
    v_pk_fma_f32 v[108:109], v[248:249], v[184:185], v[108:109]
    v_pk_fma_f32 v[108:109], v[250:251], v[186:187], v[108:109]
    v_pk_fma_f32 v[110:111], v[252:253], v[184:185], v[110:111]
    v_pk_fma_f32 v[110:111], v[254:255], v[186:187], v[110:111]
    v_add_f32 v112, v96, v97
    v_add_f32 v113, v98, v99
    v_add_f32 v114, v100, v101
    v_add_f32 v115, v102, v103
    v_add_f32 v116, v104, v105
    v_add_f32 v117, v106, v107
    v_add_f32 v118, v108, v109
    v_add_f32 v119, v110, v111
    s_nop 1
    v_permlane32_swap_b32 v112, v116
    v_permlane32_swap_b32 v113, v117
    v_permlane32_swap_b32 v114, v118
    v_permlane32_swap_b32 v115, v119
    s_nop 1
    v_add_f32 v112, v112, v116
    v_add_f32 v113, v113, v117
    v_add_f32 v114, v114, v118
    v_add_f32 v115, v115, v119
    s_nop 1
    v_permlane16_swap_b32 v112, v114
    v_permlane16_swap_b32 v113, v115
    s_nop 1
    v_add_f32 v112, v112, v114
    v_add_f32 v113, v113, v115
    ds_write_b64 v16, v[112:113]
    v_lshlrev_b32 v15, 3, v1
    s_waitcnt lgkmcnt(0)
    s_barrier
    s_cmp_lg_u32 s3, 0
    s_cbranch_scc1 L_done
    ds_read_b64 v[192:193], v15 offset:0
    ds_read_b64 v[194:195], v15 offset:512
    ds_read_b64 v[196:197], v15 offset:1024
    ds_read_b64 v[198:199], v15 offset:1536
    ds_read_b64 v[200:201], v15 offset:2048
    ds_read_b64 v[202:203], v15 offset:2560
    ds_read_b64 v[204:205], v15 offset:3072
    ds_read_b64 v[206:207], v15 offset:3584
    s_waitcnt lgkmcnt(0)
    v_pk_add_f32 v[192:193], v[192:193], v[200:201]
    v_pk_add_f32 v[194:195], v[194:195], v[202:203]
    v_pk_add_f32 v[196:197], v[196:197], v[204:205]
    v_pk_add_f32 v[198:199], v[198:199], v[206:207]
    v_pk_add_f32 v[192:193], v[192:193], v[196:197]
    v_pk_add_f32 v[194:195], v[194:195], v[198:199]
    v_pk_add_f32 v[192:193], v[192:193], v[194:195]
    v_cvt_pk_bf16_f32 v192, v192, v193
    v_min_u32 v192, -2, v192
    buffer_store_dword v192, v13, s[48:51], s7 offen sc1
    s_branch L_done
L_fail:
    s_mov_b64 exec, 1
    v_mov_b32 v20, 0x7f
    v_mov_b32 v21, 255
    buffer_store_byte v20, v21, s[52:55], 0 offen sc1
    s_mov_b64 exec, -1
L_done:
L_end:
    s_endpgm
L_codeend:

.section .rodata,"a"
.p2align 6
.amdhsa_kernel adaLN_cond__compressed_kv_cla__glu_gated_geglu__decode_kernel
  .amdhsa_next_free_vgpr 256
  .amdhsa_next_free_sgpr 102
  .amdhsa_accum_offset 256
  .amdhsa_group_segment_fixed_size 0
  .amdhsa_kernarg_size 120
  .amdhsa_user_sgpr_count 2
  .amdhsa_user_sgpr_kernarg_segment_ptr 1
  .amdhsa_system_sgpr_workgroup_id_x 1
.end_amdhsa_kernel
```
